```python
import torch

def _softmax(x, axis=-1):
    return torch.softmax(x, dim=axis)

def _gelu(x):
    return torch.nn.functional.gelu(x, approximate='tanh')

def _silu(x):
    return torch.nn.functional.silu(x)

def _sigmoid(x):
    return torch.sigmoid(x)

def _layernorm(x, axis=-1, eps=1e-05):
    m = x.mean(dim=axis, keepdim=True)
    v = x.var(dim=axis, keepdim=True, unbiased=False)
    return (x - m) / torch.sqrt(v + eps)

def _scatter_add(tgt, idx, src, axis=0):
    return tgt.clone().index_add_(axis, idx, src)

def _segment_sum(src, seg, n):
    out = torch.zeros((n,) + src.shape[1:], dtype=src.dtype)
    return out.index_add_(0, seg, src)

def _pad(x, pw):
    flat = tuple((v for pair in reversed(pw) for v in pair))
    return torch.nn.functional.pad(x, flat)
kernel_name = 'gather_scatter__tensor_product_equiv_equiformer__graph'

def setup_inputs():

    _w = lambda a: (lambda t: t.to(torch.bfloat16) if t.is_floating_point() else t)(torch.as_tensor(a))
    N, deg, C, De = (10000, 64, 64, max(16, 1))
    E = N * deg
    src = (lambda lo, hi, *s: torch.randint(lo, hi, s))(0, N, E).to(torch.int64)
    dst = (lambda lo, hi, *s: torch.randint(lo, hi, s))(0, N, E).to(torch.int64)
    rvec = (lambda *s: torch.randn(*s, dtype=torch.bfloat16) * 0.05)(E, 3).to(float)
    rn = (torch.linalg.norm(rvec, dim=-1, keepdim=True) + 1e-06).to(float)
    rhat = (rvec / rn).to(float)
    eps = torch.zeros((3, 3, 3), dtype=float)
    eps[0, 1, 2] = eps[1, 2, 0] = eps[2, 0, 1] = 1.0
    eps[0, 2, 1] = eps[2, 1, 0] = eps[1, 0, 2] = -1.0
    return {'x': _w((lambda *s: torch.randn(*s, dtype=torch.bfloat16) * 0.2)(N, 4 * C).to(float)), 'rhat': _w(rhat), 'e_attr': _w((lambda *s: torch.randn(*s, dtype=torch.bfloat16) * 0.2)(E, De).to(float)), 'src': _w(src), 'dst': _w(dst), 'w_rad': _w((lambda *s: torch.randn(*s, dtype=torch.bfloat16) * 0.2)(De, 5 * C).to(float)), 'w_si0': _w((lambda *s: torch.randn(*s, dtype=torch.bfloat16) * 0.2)(2 * C, C).to(float)), 'w_si1': _w((lambda *s: torch.randn(*s, dtype=torch.bfloat16) * 0.05)(3 * C, C).to(float)), 'cg_eps': _w(eps)}

def reference(x, rhat, e_attr, src, dst, w_rad, w_si0, w_si1, cg_eps):
    N = x.shape[0]
    C = w_si0.shape[1]
    E = rhat.shape[0]
    x0 = x[:, :C].clone()
    x1 = x[:, C:].reshape(N, 3, C)
    R = (e_attr @ w_rad).reshape(E, 5, C)
    f0 = x0[src]
    f1 = x1[src]
    Y1 = rhat
    p00_0 = f0 * R[:, 0, :]
    p11_0 = torch.einsum('ejc,ej->ec', f1, Y1) * R[:, 1, :]
    p01_1 = torch.einsum('ec,ej->ejc', f0, Y1) * R[:, 2, :][:, None, :]
    p10_1 = f1 * R[:, 3, :][:, None, :]
    p11_1 = torch.einsum('ijk,ekc,ej->eic', cg_eps, f1, Y1) * R[:, 4, :][:, None, :]
    m0 = torch.concatenate([p00_0, p11_0], axis=-1) @ w_si0
    m1 = torch.einsum('ejp,pc->ejc', torch.concatenate([p01_1, p10_1, p11_1], axis=-1), w_si1)
    agg0 = _segment_sum(m0, dst, N)
    agg1 = _segment_sum(m1.reshape(E, 3 * C), dst, N).reshape(N, 3, C)
    gate = _sigmoid(agg0)
    out1 = agg1 * gate[:, None, :]
    return torch.concatenate([agg0, out1.reshape(N, 3 * C)], axis=-1)
```

```asm
; @launch kernel=gather_scatter__tensor_product_equiv_equiformer__graph_kernel grid=(500,1,1) block=(256,1,1) lds=81920
.amdgcn_target "amdgcn-amd-amdhsa--gfx950"
.text
.globl gather_scatter__tensor_product_equiv_equiformer__graph_kernel
.p2align 8
.type gather_scatter__tensor_product_equiv_equiformer__graph_kernel,@function
gather_scatter__tensor_product_equiv_equiformer__graph_kernel:
    s_cmp_ge_u32 s2, 500
    s_cbranch_scc1 K2_end
    s_load_dwordx16 s[68:83], s[0:1], 32
    s_load_dwordx8 s[40:47], s[0:1], 0
    s_memrealtime s[48:49]
    v_lshlrev_b32 v252, 4, v0
    v_lshlrev_b32 v253, 3, v0
    v_mul_u32_u24 v254, 24, v0
    v_mul_u32_u24 v255, 12, v0
    s_mov_b32 s32, s2
    s_mul_i32 s25, s32, 10240
    s_add_u32 s26, s25, 4096
    s_add_u32 s27, s25, 8192
    s_mul_i32 s28, s32, 15360
    s_add_u32 s29, s28, 6144
    s_add_u32 s30, s28, 12288
    v_lshrrev_b32 v1, 6, v0
    s_nop 0
    v_readfirstlane_b32 s3, v1
    v_and_b32 v1, 63, v0
    s_movk_i32 s34, 4096
    s_movk_i32 s35, 8192
    s_waitcnt lgkmcnt(0)
    s_mov_b32 s52, s80
    s_and_b32 s53, s81, 0xffff
    s_mov_b32 s54, 256
    s_mov_b32 s55, 0x20000
    v_mov_b32 v244, 0
    s_xor_b32 s31, s2, 0
    s_or_b32 s31, s31, s3
    s_cmp_lg_u32 s31, 0
    s_cbranch_scc1 P1_notag
    s_and_b32 s31, s49, 15
    s_lshl_b32 s31, s31, 12
    s_lshl_b32 s49, s49, 24
    s_and_b32 s49, s49, 0xf0000000
    s_or_b32 s49, s49, s31
    s_or_b32 s49, s49, 1
    v_mov_b32 v242, s48
    v_mov_b32 v243, s49
    s_mov_b64 exec, 1
    buffer_store_dwordx2 v[242:243], v244, s[52:55], 0 offen sc1
    s_mov_b64 exec, -1
    s_nop 1
P1_notag:
    s_cmp_ge_u32 s32, 250
    s_cbranch_scc1 P1_noload
    s_mov_b32 s56, s68
    s_and_b32 s57, s69, 0xffff
    s_mov_b32 s58, 2560000
    s_mov_b32 s59, 0x20000
    buffer_load_dwordx4 v[80:83], v252, s[56:59], s25 offen
    buffer_load_dwordx4 v[84:87], v252, s[56:59], s26 offen
    buffer_load_dwordx2 v[88:89], v253, s[56:59], s27 offen
    buffer_load_dwordx2 v[242:243], v244, s[52:55], 0 offen sc1
    s_mov_b32 s60, s46
    s_and_b32 s61, s47, 0xffff
    s_mov_b32 s62, 2560000
    s_mov_b32 s63, 0x20000
    buffer_load_dwordx4 v[90:93], v252, s[60:63], s25 offen
    buffer_load_dwordx4 v[94:97], v252, s[60:63], s26 offen
    buffer_load_dwordx2 v[98:99], v253, s[60:63], s27 offen
    s_mov_b32 s64, s42
    s_and_b32 s65, s43, 0xffff
    s_mov_b32 s66, 3840000
    s_mov_b32 s67, 0x20000
    buffer_load_dwordx4 v[100:103], v254, s[64:67], s28 offen
    buffer_load_dwordx2 v[104:105], v254, s[64:67], s28 offen offset:16
    buffer_load_dwordx4 v[106:109], v254, s[64:67], s29 offen
    buffer_load_dwordx2 v[110:111], v254, s[64:67], s29 offen offset:16
    buffer_load_dwordx3 v[112:114], v255, s[64:67], s30 offen
P1_noload:
    s_mov_b32 s16, s70
    s_and_b32 s17, s71, 0xffff
    s_mov_b32 s18, 10240
    s_mov_b32 s19, 0x20000
    buffer_load_dwordx4 v[192:195], v252, s[16:19], 0 offen
    buffer_load_dwordx4 v[196:199], v252, s[16:19], s34 offen
    buffer_load_dwordx4 v[200:203], v252, s[16:19], s35 offen
    v_mov_b32 v144, 0
    v_mov_b32 v145, 0
    v_mov_b32 v146, 0
    v_mov_b32 v147, 0
    v_and_b32 v148, 1, v0
    v_lshlrev_b32 v148, 7, v148
    v_xor_b32 v148, 0x80, v148
    v_mov_b32 v149, v148
    v_mov_b32 v150, v148
    v_mov_b32 v151, v148
    v_cmp_gt_u32 vcc, 224, v0
    s_nop 1
    v_cndmask_b32 v152, 0, v148, vcc
    v_cndmask_b32 v153, 0, v148, vcc
    v_cndmask_b32 v154, 0, v148, vcc
    v_cndmask_b32 v155, 0, v148, vcc
    v_lshlrev_b32 v252, 4, v0
    v_add_u32 v255, 32768, v252
    v_mov_b32 v160, 1
    ds_write_b64 v253, v[144:145] offset:12288
    ds_write_b128 v252, v[144:147] offset:24576
    ds_write_b128 v252, v[144:147] offset:28672
    ds_write_b128 v252, v[144:147] offset:32768
    ds_write_b128 v252, v[144:147] offset:36864
    ds_write_b128 v252, v[148:151] offset:16384
    ds_write_b128 v252, v[152:155] offset:20480
    s_mov_b32 s12, s82
    s_and_b32 s13, s83, 0xffff
    s_mov_b32 s14, 33161216
    s_mov_b32 s15, 0x20000
    s_mov_b32 s8, s44
    s_and_b32 s9, s45, 0xffff
    s_mov_b32 s10, 20480000
    s_mov_b32 s11, 0x20000
    s_mov_b32 s20, s78
    s_and_b32 s21, s79, 0xffff
    s_mov_b32 s22, 5120000
    s_mov_b32 s23, 0x20000
    s_and_b32 s24, s2, 7
    s_min_u32 s25, s24, 4
    s_mul_i32 s24, s24, 62
    s_add_u32 s24, s24, s25
    s_lshr_b32 s25, s2, 3
    s_add_u32 s24, s24, s25
    s_lshl_b32 s33, s3, 7
    s_add_u32 s4, s40, s33
    s_addc_u32 s5, s41, 0
    s_sub_u32 s4, s4, 128
    s_subb_u32 s5, s5, 0
    s_and_b32 s5, s5, 0xffff
    s_or_b32 s5, s5, 262144
    s_mov_b32 s6, 64
    s_mov_b32 s7, 0x00800000
    v_lshlrev_b32 v2, 2, v1
    v_and_b32 v10, 31, v1
    v_lshlrev_b32 v10, 2, v10
    v_lshrrev_b32 v254, 5, v1
    v_add_u32 v10, s33, v10
    v_lshl_add_u32 v10, v254, 9, v10
    v_add_u32 v10, 40640, v10
    v_and_b32 v11, 3, v1
    v_lshlrev_b32 v11, 3, v11
    v_add_u32 v11, 33554400, v11
    v_mov_b32 v249, 0xdddd8888
    s_mov_b32 s36, 0
    s_mov_b32 s37, 0x007ffe00
    s_movk_i32 s40, 0x80
    v_lshlrev_b32 v245, 12, v0
    s_cmp_ge_u32 s32, 250
    s_cbranch_scc1 P1_other
    s_waitcnt lgkmcnt(0)
    s_barrier
    s_waitcnt vmcnt(12)
    v_min_u32 v80, 9999, v80
    v_mul_u32_u24 v116, 3277, v80
    v_lshrrev_b32 v116, 16, v116
    v_mul_u32_u24 v126, 20, v116
    v_lshlrev_b32 v116, 2, v116
    ds_add_rtn_u32 v164, v116, v160 offset:12288
    v_sub_u32 v126, v80, v126
    v_min_u32 v81, 9999, v81
    v_mul_u32_u24 v117, 3277, v81
    v_lshrrev_b32 v117, 16, v117
    v_mul_u32_u24 v127, 20, v117
    v_lshlrev_b32 v117, 2, v117
    ds_add_rtn_u32 v165, v117, v160 offset:12288
    v_sub_u32 v127, v81, v127
    v_min_u32 v82, 9999, v82
    v_mul_u32_u24 v118, 3277, v82
    v_lshrrev_b32 v118, 16, v118
    v_mul_u32_u24 v128, 20, v118
    v_lshlrev_b32 v118, 2, v118
    ds_add_rtn_u32 v166, v118, v160 offset:12288
    v_sub_u32 v128, v82, v128
    v_min_u32 v83, 9999, v83
    v_mul_u32_u24 v119, 3277, v83
    v_lshrrev_b32 v119, 16, v119
    v_mul_u32_u24 v129, 20, v119
    v_lshlrev_b32 v119, 2, v119
    ds_add_rtn_u32 v167, v119, v160 offset:12288
    v_sub_u32 v129, v83, v129
    v_min_u32 v84, 9999, v84
    v_mul_u32_u24 v120, 3277, v84
    v_lshrrev_b32 v120, 16, v120
    v_mul_u32_u24 v130, 20, v120
    v_lshlrev_b32 v120, 2, v120
    ds_add_rtn_u32 v168, v120, v160 offset:12288
    v_sub_u32 v130, v84, v130
    v_min_u32 v85, 9999, v85
    v_mul_u32_u24 v121, 3277, v85
    v_lshrrev_b32 v121, 16, v121
    v_mul_u32_u24 v131, 20, v121
    v_lshlrev_b32 v121, 2, v121
    ds_add_rtn_u32 v169, v121, v160 offset:12288
    v_sub_u32 v131, v85, v131
    v_min_u32 v86, 9999, v86
    v_mul_u32_u24 v122, 3277, v86
    v_lshrrev_b32 v122, 16, v122
    v_mul_u32_u24 v132, 20, v122
    v_lshlrev_b32 v122, 2, v122
    ds_add_rtn_u32 v170, v122, v160 offset:12288
    v_sub_u32 v132, v86, v132
    v_min_u32 v87, 9999, v87
    v_mul_u32_u24 v123, 3277, v87
    v_lshrrev_b32 v123, 16, v123
    v_mul_u32_u24 v133, 20, v123
    v_lshlrev_b32 v123, 2, v123
    ds_add_rtn_u32 v171, v123, v160 offset:12288
    v_sub_u32 v133, v87, v133
    v_min_u32 v88, 9999, v88
    v_mul_u32_u24 v124, 3277, v88
    v_lshrrev_b32 v124, 16, v124
    v_mul_u32_u24 v134, 20, v124
    v_lshlrev_b32 v124, 2, v124
    ds_add_rtn_u32 v172, v124, v160 offset:12288
    v_sub_u32 v134, v88, v134
    v_min_u32 v89, 9999, v89
    v_mul_u32_u24 v125, 3277, v89
    v_lshrrev_b32 v125, 16, v125
    v_mul_u32_u24 v135, 20, v125
    v_lshlrev_b32 v125, 2, v125
    ds_add_rtn_u32 v173, v125, v160 offset:12288
    v_sub_u32 v135, v89, v135
    s_waitcnt lgkmcnt(0)
    s_barrier
    s_cmp_lg_u32 s3, 0
    s_cbranch_scc1 P1_noscan
    v_lshlrev_b32 v253, 5, v1
    ds_read_b128 v[176:179], v253 offset:12288
    ds_read_b128 v[180:183], v253 offset:12304
    s_waitcnt lgkmcnt(0)
    v_mov_b32 v184, 0
    v_add_u32 v185, v184, v176
    v_add_u32 v186, v185, v177
    v_add_u32 v187, v186, v178
    v_add_u32 v188, v187, v179
    v_add_u32 v189, v188, v180
    v_add_u32 v190, v189, v181
    v_add_u32 v191, v190, v182
    v_add_u32 v240, v191, v183
    v_mov_b32 v241, v240
    s_nop 1
    v_add_u32_dpp v241, v241, v241 row_shr:1 row_mask:0xf bank_mask:0xf bound_ctrl:0
    s_nop 1
    v_add_u32_dpp v241, v241, v241 row_shr:2 row_mask:0xf bank_mask:0xf bound_ctrl:0
    s_nop 1
    v_add_u32_dpp v241, v241, v241 row_shr:4 row_mask:0xf bank_mask:0xf bound_ctrl:0
    s_nop 1
    v_add_u32_dpp v241, v241, v241 row_shr:8 row_mask:0xf bank_mask:0xf bound_ctrl:0
    s_nop 1
    v_add_u32_dpp v241, v241, v241 row_bcast:15 row_mask:0xa bank_mask:0xf
    s_nop 1
    v_add_u32_dpp v241, v241, v241 row_bcast:31 row_mask:0xc bank_mask:0xf
    v_sub_u32 v241, v241, v240
    v_add_u32 v184, v184, v241
    v_lshl_or_b32 v184, v176, 16, v184
    v_add_u32 v185, v185, v241
    v_lshl_or_b32 v185, v177, 16, v185
    v_add_u32 v186, v186, v241
    v_lshl_or_b32 v186, v178, 16, v186
    v_add_u32 v187, v187, v241
    v_lshl_or_b32 v187, v179, 16, v187
    v_add_u32 v188, v188, v241
    v_lshl_or_b32 v188, v180, 16, v188
    v_add_u32 v189, v189, v241
    v_lshl_or_b32 v189, v181, 16, v189
    v_add_u32 v190, v190, v241
    v_lshl_or_b32 v190, v182, 16, v190
    v_add_u32 v191, v191, v241
    v_lshl_or_b32 v191, v183, 16, v191
    ds_write_b128 v253, v[184:187] offset:12288
    ds_write_b128 v253, v[188:191] offset:12304
    v_lshlrev_b32 v253, 3, v0
P1_noscan:
    s_waitcnt vmcnt(11)
    s_mov_b32 s34, 0x40000
P1_t_chk:
    v_readfirstlane_b32 s39, v242
    v_readfirstlane_b32 s38, v243
    s_cmp_lg_u32 s38, 0
    s_cbranch_scc1 P1_t_go
    buffer_load_dwordx2 v[242:243], v244, s[52:55], 0 offen sc1
    s_waitcnt vmcnt(0)
    s_sub_u32 s34, s34, 1
    s_cbranch_scc0 P1_t_chk
P1_t_go:
    s_and_b32 s38, s38, 0xf000f000
    s_waitcnt lgkmcnt(0)
    s_barrier
    ds_read_b64 v[158:159], v253 offset:12288
    ds_read_b32 v80, v116 offset:12288
    ds_read_b32 v81, v117 offset:12288
    ds_read_b32 v82, v118 offset:12288
    ds_read_b32 v83, v119 offset:12288
    ds_read_b32 v84, v120 offset:12288
    ds_read_b32 v85, v121 offset:12288
    ds_read_b32 v86, v122 offset:12288
    ds_read_b32 v87, v123 offset:12288
    ds_read_b32 v88, v124 offset:12288
    ds_read_b32 v89, v125 offset:12288
    s_waitcnt lgkmcnt(10)
    v_or_b32 v156, s38, v158
    v_or_b32 v158, s38, v159
    v_mov_b32 v157, s39
    v_mov_b32 v159, s39
    s_lshl_b32 s31, s32, 12
    buffer_store_dwordx4 v[156:159], v252, s[12:15], s31 offen sc1
    v_mov_b32 v253, 40960
    s_waitcnt lgkmcnt(9)
    v_and_b32 v80, 0xffff, v80
    v_add_u32 v80, v80, v164
    v_lshl_add_u32 v80, v80, 4, v253
    s_waitcnt lgkmcnt(8)
    v_and_b32 v81, 0xffff, v81
    v_add_u32 v81, v81, v165
    v_lshl_add_u32 v81, v81, 4, v253
    s_waitcnt lgkmcnt(7)
    v_and_b32 v82, 0xffff, v82
    v_add_u32 v82, v82, v166
    v_lshl_add_u32 v82, v82, 4, v253
    s_waitcnt lgkmcnt(6)
    v_and_b32 v83, 0xffff, v83
    v_add_u32 v83, v83, v167
    v_lshl_add_u32 v83, v83, 4, v253
    s_waitcnt lgkmcnt(5)
    v_and_b32 v84, 0xffff, v84
    v_add_u32 v84, v84, v168
    v_lshl_add_u32 v84, v84, 4, v253
    s_waitcnt lgkmcnt(4)
    v_and_b32 v85, 0xffff, v85
    v_add_u32 v85, v85, v169
    v_lshl_add_u32 v85, v85, 4, v253
    s_waitcnt lgkmcnt(3)
    v_and_b32 v86, 0xffff, v86
    v_add_u32 v86, v86, v170
    v_lshl_add_u32 v86, v86, 4, v253
    s_waitcnt lgkmcnt(2)
    v_and_b32 v87, 0xffff, v87
    v_add_u32 v87, v87, v171
    v_lshl_add_u32 v87, v87, 4, v253
    s_waitcnt lgkmcnt(1)
    v_and_b32 v88, 0xffff, v88
    v_add_u32 v88, v88, v172
    v_lshl_add_u32 v88, v88, 4, v253
    s_waitcnt lgkmcnt(0)
    v_and_b32 v89, 0xffff, v89
    v_add_u32 v89, v89, v173
    v_lshl_add_u32 v89, v89, 4, v253
    s_mul_i32 s31, s32, 2560
    s_mov_b32 s30, 0xffff
    s_sub_u32 s29, 1048572, s31
    v_lshlrev_b32 v240, 2, v0
    v_sub_u32 v240, s29, v240
    v_lshrrev_b32 v241, 16, v240
    v_lshlrev_b32 v240, 16, v240
    s_waitcnt vmcnt(7)
    v_min_u32 v90, 9999, v90
    v_lshl_or_b32 v210, v90, 9, v241
    v_lshl_or_b32 v210, v126, 26, v210
    v_mov_b32 v208, v100
    v_and_or_b32 v209, v101, s30, v240
    v_add_u32 v209, 196608, v209
    ds_write_b96 v80, v[208:210]
    v_min_u32 v91, 9999, v91
    v_lshl_or_b32 v214, v91, 9, v241
    v_lshl_or_b32 v214, v127, 26, v214
    v_alignbit_b32 v212, v102, v101, 16
    v_lshrrev_b32 v213, 16, v102
    v_or_b32 v213, v213, v240
    v_add_u32 v213, 131072, v213
    ds_write_b96 v81, v[212:214]
    v_min_u32 v92, 9999, v92
    v_lshl_or_b32 v218, v92, 9, v241
    v_lshl_or_b32 v218, v128, 26, v218
    v_mov_b32 v216, v103
    v_and_or_b32 v217, v104, s30, v240
    v_add_u32 v217, 65536, v217
    ds_write_b96 v82, v[216:218]
    v_min_u32 v93, 9999, v93
    v_lshl_or_b32 v222, v93, 9, v241
    v_lshl_or_b32 v222, v129, 26, v222
    v_alignbit_b32 v220, v105, v104, 16
    v_lshrrev_b32 v221, 16, v105
    v_or_b32 v221, v221, v240
    ds_write_b96 v83, v[220:222]
    s_sub_u32 s29, 1047548, s31
    v_lshlrev_b32 v240, 2, v0
    v_sub_u32 v240, s29, v240
    v_lshrrev_b32 v241, 16, v240
    v_lshlrev_b32 v240, 16, v240
    s_waitcnt vmcnt(5)
    v_min_u32 v94, 9999, v94
    v_lshl_or_b32 v226, v94, 9, v241
    v_lshl_or_b32 v226, v130, 26, v226
    v_mov_b32 v224, v106
    v_and_or_b32 v225, v107, s30, v240
    v_add_u32 v225, 196608, v225
    ds_write_b96 v84, v[224:226]
    v_min_u32 v95, 9999, v95
    v_lshl_or_b32 v230, v95, 9, v241
    v_lshl_or_b32 v230, v131, 26, v230
    v_alignbit_b32 v228, v108, v107, 16
    v_lshrrev_b32 v229, 16, v108
    v_or_b32 v229, v229, v240
    v_add_u32 v229, 131072, v229
    ds_write_b96 v85, v[228:230]
    v_min_u32 v96, 9999, v96
    v_lshl_or_b32 v234, v96, 9, v241
    v_lshl_or_b32 v234, v132, 26, v234
    v_mov_b32 v232, v109
    v_and_or_b32 v233, v110, s30, v240
    v_add_u32 v233, 65536, v233
    ds_write_b96 v86, v[232:234]
    v_min_u32 v97, 9999, v97
    v_lshl_or_b32 v238, v97, 9, v241
    v_lshl_or_b32 v238, v133, 26, v238
    v_alignbit_b32 v236, v111, v110, 16
    v_lshrrev_b32 v237, 16, v111
    v_or_b32 v237, v237, v240
    ds_write_b96 v87, v[236:238]
    s_sub_u32 s29, 1046526, s31
    v_lshlrev_b32 v240, 1, v0
    v_sub_u32 v240, s29, v240
    v_lshrrev_b32 v241, 16, v240
    v_lshlrev_b32 v240, 16, v240
    s_waitcnt vmcnt(4)
    v_min_u32 v98, 9999, v98
    v_lshl_or_b32 v210, v98, 9, v241
    v_lshl_or_b32 v210, v134, 26, v210
    v_mov_b32 v208, v112
    v_and_or_b32 v209, v113, s30, v240
    v_add_u32 v209, 65536, v209
    ds_write_b96 v88, v[208:210]
    v_min_u32 v99, 9999, v99
    v_lshl_or_b32 v214, v99, 9, v241
    v_lshl_or_b32 v214, v135, 26, v214
    v_alignbit_b32 v212, v114, v113, 16
    v_lshrrev_b32 v213, 16, v114
    v_or_b32 v213, v213, v240
    ds_write_b96 v89, v[212:214]
    s_mul_i32 s31, s32, 40960
    s_add_u32 s31, s31, 2097152
    s_waitcnt vmcnt(1)
    ds_write_b128 v252, v[192:195]
    ds_write_b128 v252, v[196:199] offset:4096
    ds_write_b128 v252, v[200:203] offset:8192
    s_lshl_b32 s33, s24, 3
    buffer_load_dwordx2 v[246:247], v245, s[12:15], s33 offen sc1
    s_waitcnt lgkmcnt(0)
    v_mov_b32 v83, s39
    v_mov_b32 v87, s39
    v_mov_b32 v91, s39
    v_mov_b32 v95, s39
    v_mov_b32 v99, s39
    v_mov_b32 v103, s39
    v_mov_b32 v107, s39
    v_mov_b32 v111, s39
    v_mov_b32 v115, s39
    v_mov_b32 v119, s39
    s_barrier
    ds_read_b96 v[80:82], v255 offset:8192
    ds_read_b96 v[84:86], v255 offset:12288
    ds_read_b96 v[88:90], v255 offset:16384
    ds_read_b96 v[92:94], v255 offset:20480
    ds_read_b96 v[96:98], v255 offset:24576
    ds_read_b96 v[100:102], v255 offset:28672
    ds_read_b96 v[104:106], v255 offset:32768
    ds_read_b96 v[108:110], v255 offset:36864
    ds_read_b96 v[112:114], v255 offset:40960
    ds_read_b96 v[116:118], v255 offset:45056
    s_waitcnt lgkmcnt(9)
    buffer_store_dwordx4 v[80:83], v252, s[12:15], s31 offen sc1
    s_add_u32 s31, s31, 4096
    s_waitcnt lgkmcnt(8)
    buffer_store_dwordx4 v[84:87], v252, s[12:15], s31 offen sc1
    s_add_u32 s31, s31, 4096
    s_waitcnt lgkmcnt(7)
    buffer_store_dwordx4 v[88:91], v252, s[12:15], s31 offen sc1
    s_add_u32 s31, s31, 4096
    s_waitcnt lgkmcnt(6)
    buffer_store_dwordx4 v[92:95], v252, s[12:15], s31 offen sc1
    s_add_u32 s31, s31, 4096
    s_waitcnt lgkmcnt(5)
    buffer_store_dwordx4 v[96:99], v252, s[12:15], s31 offen sc1
    s_add_u32 s31, s31, 4096
    s_waitcnt lgkmcnt(4)
    buffer_store_dwordx4 v[100:103], v252, s[12:15], s31 offen sc1
    s_add_u32 s31, s31, 4096
    s_waitcnt lgkmcnt(3)
    buffer_store_dwordx4 v[104:107], v252, s[12:15], s31 offen sc1
    s_add_u32 s31, s31, 4096
    s_waitcnt lgkmcnt(2)
    buffer_store_dwordx4 v[108:111], v252, s[12:15], s31 offen sc1
    s_add_u32 s31, s31, 4096
    s_waitcnt lgkmcnt(1)
    buffer_store_dwordx4 v[112:115], v252, s[12:15], s31 offen sc1
    s_add_u32 s31, s31, 4096
    s_waitcnt lgkmcnt(0)
    buffer_store_dwordx4 v[116:119], v252, s[12:15], s31 offen sc1
    s_branch P1_join
P1_other:
    s_cmp_ge_u32 s32, 254
    s_cbranch_scc1 P1_nopack
    s_sub_u32 s25, s32, 250
    v_and_b32 v253, 15, v1
    v_lshrrev_b32 v254, 4, v1
    s_lshl_b32 s26, s25, 5
    v_lshlrev_b32 v253, 1, v253
    v_add_u32 v253, s26, v253
    v_lshl_add_u32 v253, v254, 10, v253
    v_lshlrev_b32 v254, 4, v1
    s_mul_i32 s26, s25, 10240
    s_add_u32 s26, s26, 1048576
    s_lshl_b32 s27, s3, 10
    s_add_u32 s26, s26, s27
    s_mov_b32 s56, s72
    s_and_b32 s57, s73, 0xffff
    s_mov_b32 s58, 16384
    s_mov_b32 s59, 0x20000
    s_mov_b32 s60, s74
    s_and_b32 s61, s75, 0xffff
    s_mov_b32 s62, 24576
    s_mov_b32 s63, 0x20000
    s_lshl_b32 s27, s3, 12
    s_add_u32 s28, s27, 16384
    buffer_load_ushort v80, v253, s[56:59], s27 offen offset:0
    buffer_load_ushort v81, v253, s[56:59], s27 offen offset:128
    buffer_load_ushort v82, v253, s[56:59], s27 offen offset:256
    buffer_load_ushort v83, v253, s[56:59], s27 offen offset:384
    buffer_load_ushort v84, v253, s[56:59], s27 offen offset:512
    buffer_load_ushort v85, v253, s[56:59], s27 offen offset:640
    buffer_load_ushort v86, v253, s[56:59], s27 offen offset:768
    buffer_load_ushort v87, v253, s[56:59], s27 offen offset:896
    buffer_load_ushort v88, v253, s[60:63], s27 offen offset:0
    buffer_load_ushort v89, v253, s[60:63], s27 offen offset:128
    buffer_load_ushort v90, v253, s[60:63], s27 offen offset:256
    buffer_load_ushort v91, v253, s[60:63], s27 offen offset:384
    buffer_load_ushort v92, v253, s[60:63], s27 offen offset:512
    buffer_load_ushort v93, v253, s[60:63], s27 offen offset:640
    buffer_load_ushort v94, v253, s[60:63], s27 offen offset:768
    buffer_load_ushort v95, v253, s[60:63], s27 offen offset:896
    buffer_load_ushort v96, v253, s[60:63], s28 offen offset:0
    buffer_load_ushort v97, v253, s[60:63], s28 offen offset:128
    buffer_load_ushort v98, v253, s[60:63], s28 offen offset:256
    buffer_load_ushort v99, v253, s[60:63], s28 offen offset:384
    buffer_load_ushort v100, v253, s[60:63], s28 offen offset:512
    buffer_load_ushort v101, v253, s[60:63], s28 offen offset:640
    buffer_load_ushort v102, v253, s[60:63], s28 offen offset:768
    buffer_load_ushort v103, v253, s[60:63], s28 offen offset:896
    s_waitcnt vmcnt(0)
    v_lshl_or_b32 v104, v81, 16, v80
    v_lshl_or_b32 v105, v83, 16, v82
    v_lshl_or_b32 v106, v85, 16, v84
    v_lshl_or_b32 v107, v87, 16, v86
    buffer_store_dwordx4 v[104:107], v254, s[12:15], s26 offen sc1
    s_add_u32 s26, s26, 4096
    v_lshl_or_b32 v108, v89, 16, v88
    v_lshl_or_b32 v109, v91, 16, v90
    v_lshl_or_b32 v110, v93, 16, v92
    v_lshl_or_b32 v111, v95, 16, v94
    buffer_store_dwordx4 v[108:111], v254, s[12:15], s26 offen sc1
    s_add_u32 s26, s26, 4096
    v_lshl_or_b32 v112, v97, 16, v96
    v_lshl_or_b32 v113, v99, 16, v98
    v_lshl_or_b32 v114, v101, 16, v100
    v_lshl_or_b32 v115, v103, 16, v102
    s_cmp_ge_u32 s3, 2
    s_cbranch_scc1 P1_nopack
    buffer_store_dwordx4 v[112:115], v254, s[12:15], s26 offen sc1
P1_nopack:
    v_mov_b32 v158, 0
    v_mov_b32 v159, 0
    buffer_load_dwordx2 v[242:243], v244, s[52:55], 0 offen sc1
    s_waitcnt vmcnt(0)
    s_mov_b32 s34, 0x40000
P1_u_chk:
    v_readfirstlane_b32 s39, v242
    v_readfirstlane_b32 s38, v243
    s_cmp_lg_u32 s38, 0
    s_cbranch_scc1 P1_u_go
    buffer_load_dwordx2 v[242:243], v244, s[52:55], 0 offen sc1
    s_waitcnt vmcnt(0)
    s_sub_u32 s34, s34, 1
    s_cbranch_scc0 P1_u_chk
P1_u_go:
    s_and_b32 s38, s38, 0xf000f000
    ds_write_b128 v252, v[192:195]
    ds_write_b128 v252, v[196:199] offset:4096
    ds_write_b128 v252, v[200:203] offset:8192
    s_waitcnt lgkmcnt(0)
    s_barrier
    s_cmp_ge_u32 s32, 254
    s_cbranch_scc1 P1_nopub
    v_or_b32 v156, s38, v158
    v_or_b32 v158, s38, v159
    v_mov_b32 v157, s39
    v_mov_b32 v159, s39
    s_lshl_b32 s31, s32, 12
    buffer_store_dwordx4 v[156:159], v252, s[12:15], s31 offen sc1
P1_nopub:
    v_mov_b32 v246, 0
    v_not_b32 v247, s39
P1_join:
    s_mov_b32 s30, 0x4c132220
    s_mov_b32 s31, 0x14c3c143
    s_lshl_b32 s33, s3, 4
    s_lshr_b64 s[30:31], s[30:31], s33
    v_lshrrev_b32 v254, 5, v1
    v_lshlrev_b32 v254, 2, v254
    v_and_b32 v253, 31, v1
    v_lshlrev_b32 v253, 2, v253
    v_add_u32 v192, 0, v254
    v_lshrrev_b32 v192, v192, s30
    v_bfe_u32 v193, v192, 3, 1
    v_and_b32 v192, 7, v192
    v_lshl_add_u32 v192, v192, 7, v253
    v_mul_u32_u24 v193, 0x8000, v193
    v_lshl_or_b32 v193, v193, 16, v193
    ds_read_b32 v32, v192 offset:0
    ds_read_b32 v33, v192 offset:640
    ds_read_b32 v34, v192 offset:1280
    ds_read_b32 v35, v192 offset:1920
    ds_read_b32 v36, v192 offset:2560
    ds_read_b32 v37, v192 offset:3200
    ds_read_b32 v38, v192 offset:3840
    ds_read_b32 v39, v192 offset:4480
    ds_read_b32 v40, v192 offset:5120
    ds_read_b32 v41, v192 offset:5760
    ds_read_b32 v42, v192 offset:6400
    ds_read_b32 v43, v192 offset:7040
    ds_read_b32 v44, v192 offset:7680
    ds_read_b32 v45, v192 offset:8320
    ds_read_b32 v46, v192 offset:8960
    ds_read_b32 v47, v192 offset:9600
    v_add_u32 v196, 8, v254
    v_lshrrev_b32 v196, v196, s30
    v_bfe_u32 v197, v196, 3, 1
    v_and_b32 v196, 7, v196
    v_lshl_add_u32 v196, v196, 7, v253
    v_mul_u32_u24 v197, 0x8000, v197
    v_lshl_or_b32 v197, v197, 16, v197
    ds_read_b32 v64, v196 offset:0
    ds_read_b32 v65, v196 offset:640
    ds_read_b32 v66, v196 offset:1280
    ds_read_b32 v67, v196 offset:1920
    ds_read_b32 v68, v196 offset:2560
    ds_read_b32 v69, v196 offset:3200
    ds_read_b32 v70, v196 offset:3840
    ds_read_b32 v71, v196 offset:4480
    ds_read_b32 v72, v196 offset:5120
    ds_read_b32 v73, v196 offset:5760
    ds_read_b32 v74, v196 offset:6400
    ds_read_b32 v75, v196 offset:7040
    ds_read_b32 v76, v196 offset:7680
    ds_read_b32 v77, v196 offset:8320
    ds_read_b32 v78, v196 offset:8960
    ds_read_b32 v79, v196 offset:9600
    s_waitcnt lgkmcnt(15)
    v_xor_b32 v32, v32, v193
    v_lshlrev_b32 v16, 16, v32
    v_and_b32 v32, 0xffff0000, v32
    v_xor_b32 v33, v33, v193
    v_lshlrev_b32 v17, 16, v33
    v_and_b32 v33, 0xffff0000, v33
    v_xor_b32 v34, v34, v193
    v_lshlrev_b32 v18, 16, v34
    v_and_b32 v34, 0xffff0000, v34
    v_xor_b32 v35, v35, v193
    v_lshlrev_b32 v19, 16, v35
    v_and_b32 v35, 0xffff0000, v35
    s_waitcnt lgkmcnt(15)
    v_xor_b32 v36, v36, v193
    v_lshlrev_b32 v20, 16, v36
    v_and_b32 v36, 0xffff0000, v36
    v_xor_b32 v37, v37, v193
    v_lshlrev_b32 v21, 16, v37
    v_and_b32 v37, 0xffff0000, v37
    v_xor_b32 v38, v38, v193
    v_lshlrev_b32 v22, 16, v38
    v_and_b32 v38, 0xffff0000, v38
    v_xor_b32 v39, v39, v193
    v_lshlrev_b32 v23, 16, v39
    v_and_b32 v39, 0xffff0000, v39
    s_waitcnt lgkmcnt(15)
    v_xor_b32 v40, v40, v193
    v_lshlrev_b32 v24, 16, v40
    v_and_b32 v40, 0xffff0000, v40
    v_xor_b32 v41, v41, v193
    v_lshlrev_b32 v25, 16, v41
    v_and_b32 v41, 0xffff0000, v41
    v_xor_b32 v42, v42, v193
    v_lshlrev_b32 v26, 16, v42
    v_and_b32 v42, 0xffff0000, v42
    v_xor_b32 v43, v43, v193
    v_lshlrev_b32 v27, 16, v43
    v_and_b32 v43, 0xffff0000, v43
    s_waitcnt lgkmcnt(15)
    v_xor_b32 v44, v44, v193
    v_lshlrev_b32 v28, 16, v44
    v_and_b32 v44, 0xffff0000, v44
    v_xor_b32 v45, v45, v193
    v_lshlrev_b32 v29, 16, v45
    v_and_b32 v45, 0xffff0000, v45
    v_xor_b32 v46, v46, v193
    v_lshlrev_b32 v30, 16, v46
    v_and_b32 v46, 0xffff0000, v46
    v_xor_b32 v47, v47, v193
    v_lshlrev_b32 v31, 16, v47
    v_and_b32 v47, 0xffff0000, v47
    s_waitcnt lgkmcnt(12)
    v_xor_b32 v64, v64, v197
    v_lshlrev_b32 v48, 16, v64
    v_and_b32 v64, 0xffff0000, v64
    v_xor_b32 v65, v65, v197
    v_lshlrev_b32 v49, 16, v65
    v_and_b32 v65, 0xffff0000, v65
    v_xor_b32 v66, v66, v197
    v_lshlrev_b32 v50, 16, v66
    v_and_b32 v66, 0xffff0000, v66
    v_xor_b32 v67, v67, v197
    v_lshlrev_b32 v51, 16, v67
    v_and_b32 v67, 0xffff0000, v67
    s_waitcnt lgkmcnt(8)
    v_xor_b32 v68, v68, v197
    v_lshlrev_b32 v52, 16, v68
    v_and_b32 v68, 0xffff0000, v68
    v_xor_b32 v69, v69, v197
    v_lshlrev_b32 v53, 16, v69
    v_and_b32 v69, 0xffff0000, v69
    v_xor_b32 v70, v70, v197
    v_lshlrev_b32 v54, 16, v70
    v_and_b32 v70, 0xffff0000, v70
    v_xor_b32 v71, v71, v197
    v_lshlrev_b32 v55, 16, v71
    v_and_b32 v71, 0xffff0000, v71
    s_waitcnt lgkmcnt(4)
    v_xor_b32 v72, v72, v197
    v_lshlrev_b32 v56, 16, v72
    v_and_b32 v72, 0xffff0000, v72
    v_xor_b32 v73, v73, v197
    v_lshlrev_b32 v57, 16, v73
    v_and_b32 v73, 0xffff0000, v73
    v_xor_b32 v74, v74, v197
    v_lshlrev_b32 v58, 16, v74
    v_and_b32 v74, 0xffff0000, v74
    v_xor_b32 v75, v75, v197
    v_lshlrev_b32 v59, 16, v75
    v_and_b32 v75, 0xffff0000, v75
    s_waitcnt lgkmcnt(0)
    v_xor_b32 v76, v76, v197
    v_lshlrev_b32 v60, 16, v76
    v_and_b32 v76, 0xffff0000, v76
    v_xor_b32 v77, v77, v197
    v_lshlrev_b32 v61, 16, v77
    v_and_b32 v77, 0xffff0000, v77
    v_xor_b32 v78, v78, v197
    v_lshlrev_b32 v62, 16, v78
    v_and_b32 v78, 0xffff0000, v78
    v_xor_b32 v79, v79, v197
    v_lshlrev_b32 v63, 16, v79
    v_and_b32 v79, 0xffff0000, v79
    ds_write_b128 v252, v[144:147] offset:40960
    ds_write_b128 v252, v[144:147] offset:45056
    ds_write_b128 v252, v[144:147] offset:49152
    ds_write_b128 v252, v[144:147] offset:53248
    ds_write_b128 v252, v[144:147] offset:57344
    ds_write_b128 v255, v[144:147] offset:28672
    ds_write_b128 v255, v[144:147] offset:32768
    ds_write_b128 v255, v[144:147] offset:36864
    ds_write_b128 v255, v[144:147] offset:40960
    ds_write_b128 v255, v[144:147] offset:45056
    s_lshl_b32 s33, s24, 3
    v_mul_u32_u24 v254, 40960, v0
    v_add_u32 v254, 2097152, v254
    v_mov_b32 v13, 0
    s_mov_b32 s34, 0x40000
    s_mov_b32 s30, 0xf000f000
    v_cmp_gt_u32 vcc, 250, v0
    s_mov_b64 exec, vcc
    s_waitcnt vmcnt(10)
    s_branch P1_pchk
P1_poll:
    buffer_load_dwordx2 v[246:247], v245, s[12:15], s33 offen sc1
    s_waitcnt vmcnt(0)
P1_pchk:
    v_and_b32 v14, s30, v246
    v_cmp_ne_u32 vcc, s38, v14
    v_cmp_ne_u32 s[52:53], s39, v247
    v_mov_b32 v13, v246
    s_or_b64 exec, vcc, s[52:53]
    s_cbranch_execz P1_go
    s_sub_u32 s34, s34, 1
    s_cbranch_scc0 P1_poll
    v_mov_b32 v13, 0
P1_go:
    s_mov_b64 exec, -1
    v_and_b32 v14, 0xfff, v13
    v_bfe_u32 v13, v13, 16, 12
    v_mad_u32_u24 v14, v14, 16, v254
    s_branch K2_scan
K2_batch:
    v_mov_b32 v144, 0
    v_mov_b32 v145, 0
    v_mov_b32 v146, 0
    v_mov_b32 v147, 0
    v_and_b32 v148, 1, v0
    v_lshlrev_b32 v148, 7, v148
    v_xor_b32 v148, 0x80, v148
    v_mov_b32 v149, v148
    v_mov_b32 v150, v148
    v_mov_b32 v151, v148
    v_cmp_gt_u32 vcc, 224, v0
    s_nop 1
    v_cndmask_b32 v152, 0, v148, vcc
    v_cndmask_b32 v153, 0, v148, vcc
    v_cndmask_b32 v154, 0, v148, vcc
    v_cndmask_b32 v155, 0, v148, vcc
    v_lshlrev_b32 v252, 4, v0
    v_add_u32 v255, 32768, v252
    v_mov_b32 v160, 1
    ds_write_b128 v252, v[148:151] offset:16384
    ds_write_b128 v252, v[152:155] offset:20480
    ds_write_b128 v252, v[144:147] offset:24576
    ds_write_b128 v252, v[144:147] offset:28672
    ds_write_b128 v252, v[144:147] offset:32768
    ds_write_b128 v252, v[144:147] offset:36864
    ds_write_b128 v252, v[144:147] offset:40960
    ds_write_b128 v252, v[144:147] offset:45056
    ds_write_b128 v252, v[144:147] offset:49152
    ds_write_b128 v252, v[144:147] offset:53248
    ds_write_b128 v252, v[144:147] offset:57344
    ds_write_b128 v255, v[144:147] offset:28672
    ds_write_b128 v255, v[144:147] offset:32768
    ds_write_b128 v255, v[144:147] offset:36864
    ds_write_b128 v255, v[144:147] offset:40960
    ds_write_b128 v255, v[144:147] offset:45056
K2_scan:
    v_mov_b32 v161, v13
    s_nop 1
    v_add_u32_dpp v161, v161, v161 row_shr:1 row_mask:0xf bank_mask:0xf bound_ctrl:0
    s_nop 1
    v_add_u32_dpp v161, v161, v161 row_shr:2 row_mask:0xf bank_mask:0xf bound_ctrl:0
    s_nop 1
    v_add_u32_dpp v161, v161, v161 row_shr:4 row_mask:0xf bank_mask:0xf bound_ctrl:0
    s_nop 1
    v_add_u32_dpp v161, v161, v161 row_shr:8 row_mask:0xf bank_mask:0xf bound_ctrl:0
    s_nop 1
    v_add_u32_dpp v161, v161, v161 row_bcast:15 row_mask:0xa bank_mask:0xf
    s_nop 1
    v_add_u32_dpp v161, v161, v161 row_bcast:31 row_mask:0xc bank_mask:0xf
    s_lshl_b32 s33, s3, 2
    v_mov_b32 v254, s33
    v_cmp_eq_u32 vcc, 63, v1
    s_mov_b64 exec, vcc
    ds_write_b32 v254, v161 offset:16128
    s_mov_b64 exec, -1
    v_sub_u32 v161, v161, v13
    v_mov_b32 v254, 0
    s_waitcnt lgkmcnt(0)
    s_barrier
    ds_read_b128 v[144:147], v254 offset:16128
    s_waitcnt lgkmcnt(0)
    v_readfirstlane_b32 s52, v144
    v_readfirstlane_b32 s53, v145
    v_readfirstlane_b32 s54, v146
    v_readfirstlane_b32 s55, v147
    s_add_u32 s53, s53, s52
    s_add_u32 s54, s54, s53
    s_add_u32 s55, s55, s54
    s_mov_b32 s33, 0
    s_cmp_eq_u32 s3, 1
    s_cselect_b32 s33, s52, s33
    s_cmp_eq_u32 s3, 2
    s_cselect_b32 s33, s53, s33
    s_cmp_eq_u32 s3, 3
    s_cselect_b32 s33, s54, s33
    v_add_u32 v161, s33, v161
    s_cmp_gt_u32 s55, 1440
    s_cselect_b32 s32, 1, 0
    s_min_u32 s26, s55, 1440
    v_sub_u32 v15, 1440, v161
    v_max_i32 v15, 0, v15
    v_min_u32 v15, v15, v13
    v_lshlrev_b32 v162, 2, v161
    v_mov_b32 v163, v14
    v_mov_b32 v164, v15
K2_exp:
    v_cmpx_lt_i32 vcc, 0, v164
    s_cbranch_execz K2_exp_done
    ds_write_b32 v162, v163 offset:10240
    v_add_u32 v163, 16, v163
    v_cmpx_lt_i32 vcc, 1, v164
    s_cbranch_execz K2_exp_done
    ds_write_b32 v162, v163 offset:10244
    v_add_u32 v163, 16, v163
    v_cmpx_lt_i32 vcc, 2, v164
    s_cbranch_execz K2_exp_done
    ds_write_b32 v162, v163 offset:10248
    v_add_u32 v163, 16, v163
    v_cmpx_lt_i32 vcc, 3, v164
    s_cbranch_execz K2_exp_done
    ds_write_b32 v162, v163 offset:10252
    v_add_u32 v163, 16, v163
    v_add_u32 v162, 16, v162
    v_subrev_u32 v164, 4, v164
    s_branch K2_exp
K2_exp_done:
    s_mov_b64 exec, -1
    v_lshlrev_b32 v162, 2, v0
    s_sub_i32 s33, s26, 0
    v_cmp_gt_i32 s[56:57], s33, v0
    s_sub_i32 s33, s26, 256
    v_cmp_gt_i32 s[58:59], s33, v0
    s_sub_i32 s33, s26, 512
    v_cmp_gt_i32 s[60:61], s33, v0
    s_sub_i32 s33, s26, 768
    v_cmp_gt_i32 s[62:63], s33, v0
    s_sub_i32 s33, s26, 1024
    v_cmp_gt_i32 s[64:65], s33, v0
    s_sub_i32 s33, s26, 1280
    v_cmp_gt_i32 s[66:67], s33, v0
    s_waitcnt lgkmcnt(0)
    s_barrier
    ds_read_b32 v124, v162 offset:10240
    ds_read_b32 v125, v162 offset:11264
    ds_read_b32 v126, v162 offset:12288
    ds_read_b32 v127, v162 offset:13312
    ds_read_b32 v128, v162 offset:14336
    ds_read_b32 v129, v162 offset:15360
    s_mov_b64 exec, s[56:57]
    s_cbranch_execz K2_ml_done
    s_waitcnt lgkmcnt(5)
    buffer_load_dwordx4 v[80:83], v124, s[12:15], 0 offen sc1
    s_mov_b64 exec, s[58:59]
    s_cbranch_execz K2_ml_done
    s_waitcnt lgkmcnt(4)
    buffer_load_dwordx4 v[84:87], v125, s[12:15], 0 offen sc1
    s_mov_b64 exec, s[60:61]
    s_cbranch_execz K2_ml_done
    s_waitcnt lgkmcnt(3)
    buffer_load_dwordx4 v[88:91], v126, s[12:15], 0 offen sc1
    s_mov_b64 exec, s[62:63]
    s_cbranch_execz K2_ml_done
    s_waitcnt lgkmcnt(2)
    buffer_load_dwordx4 v[92:95], v127, s[12:15], 0 offen sc1
    s_mov_b64 exec, s[64:65]
    s_cbranch_execz K2_ml_done
    s_waitcnt lgkmcnt(1)
    buffer_load_dwordx4 v[96:99], v128, s[12:15], 0 offen sc1
    s_mov_b64 exec, s[66:67]
    s_cbranch_execz K2_ml_done
    s_waitcnt lgkmcnt(0)
    buffer_load_dwordx4 v[100:103], v129, s[12:15], 0 offen sc1
K2_ml_done:
    s_mov_b64 exec, -1
    v_lshlrev_b32 v130, 12, v1
    v_add_u32 v130, 1024000, v130
    s_mov_b64 s[68:69], 15
    s_mov_b64 exec, 15
    buffer_load_dwordx4 v[104:107], v130, s[12:15], 0 offen sc1
    s_mov_b64 exec, -1
    v_lshrrev_b32 v254, 5, v1
    v_lshlrev_b32 v3, 4, v254
    v_add_u32 v3, 16384, v3
    v_bfe_u32 v255, v1, 2, 2
    v_lshl_add_u32 v4, v254, 3, v255
    v_lshlrev_b32 v4, 7, v4
    v_lshrrev_b32 v5, 1, v255
    v_xor_b32 v5, v5, v255
    v_and_b32 v5, 1, v5
    v_lshl_add_u32 v4, v5, 6, v4
    v_bfe_u32 v255, v1, 4, 1
    v_lshl_add_u32 v4, v255, 5, v4
    v_and_b32 v255, 3, v1
    v_lshl_add_u32 v4, v255, 3, v4
    v_xor_b32 v5, 64, v4
    v_lshrrev_b32 v254, 2, v1
    v_lshrrev_b32 v7, 1, v254
    v_xor_b32 v7, v7, v254
    v_and_b32 v7, 1, v7
    v_lshlrev_b32 v6, 7, v254
    v_lshl_add_u32 v6, v7, 6, v6
    v_lshl_add_u32 v6, v255, 4, v6
    s_lshl_b32 s33, s3, 11
    v_add_u32 v6, s33, v6
    v_xor_b32 v7, 64, v6
    v_lshrrev_b32 v9, 2, v0
    v_lshlrev_b32 v8, 3, v9
    v_and_b32 v253, 31, v1
    v_lshlrev_b32 v254, 3, v253
    v_add_u32 v254, 39936, v254
    v_cmp_lt_u32 s[54:55], 31, v1
    s_mov_b32 s34, 0x40000
K2_mv:
    s_waitcnt vmcnt(0)
    s_mov_b32 s33, 0
    s_mov_b64 exec, s[56:57]
    v_cmpx_ne_u32 vcc, s39, v83
    s_cbranch_execz K2_mv0
    buffer_load_dwordx4 v[80:83], v124, s[12:15], 0 offen sc1
    s_mov_b32 s33, 1
K2_mv0:
    s_mov_b64 exec, s[58:59]
    v_cmpx_ne_u32 vcc, s39, v87
    s_cbranch_execz K2_mv1
    buffer_load_dwordx4 v[84:87], v125, s[12:15], 0 offen sc1
    s_mov_b32 s33, 1
K2_mv1:
    s_mov_b64 exec, s[60:61]
    v_cmpx_ne_u32 vcc, s39, v91
    s_cbranch_execz K2_mv2
    buffer_load_dwordx4 v[88:91], v126, s[12:15], 0 offen sc1
    s_mov_b32 s33, 1
K2_mv2:
    s_mov_b64 exec, s[62:63]
    v_cmpx_ne_u32 vcc, s39, v95
    s_cbranch_execz K2_mv3
    buffer_load_dwordx4 v[92:95], v127, s[12:15], 0 offen sc1
    s_mov_b32 s33, 1
K2_mv3:
    s_mov_b64 exec, s[64:65]
    v_cmpx_ne_u32 vcc, s39, v99
    s_cbranch_execz K2_mv4
    buffer_load_dwordx4 v[96:99], v128, s[12:15], 0 offen sc1
    s_mov_b32 s33, 1
K2_mv4:
    s_mov_b64 exec, s[66:67]
    v_cmpx_ne_u32 vcc, s39, v103
    s_cbranch_execz K2_mv5
    buffer_load_dwordx4 v[100:103], v129, s[12:15], 0 offen sc1
    s_mov_b32 s33, 1
K2_mv5:
    s_mov_b64 exec, s[68:69]
    v_cmpx_ne_u32 vcc, s39, v107
    s_cbranch_execz K2_mv6
    buffer_load_dwordx4 v[104:107], v130, s[12:15], 0 offen sc1
    s_mov_b32 s33, 1
K2_mv6:
    s_mov_b64 exec, -1
    s_cmp_eq_u32 s33, 0
    s_cbranch_scc1 K2_mvok
    s_sub_u32 s34, s34, 1
    s_cbranch_scc0 K2_mv
    s_waitcnt vmcnt(0)
K2_mvok:
    s_mov_b64 exec, s[56:57]
    s_cbranch_execz K2_cl_done
    v_lshrrev_b32 v112, 23, v82
    ds_add_rtn_u32 v83, v112, v160 offset:39936
    s_mov_b64 exec, s[58:59]
    s_cbranch_execz K2_cl_done
    v_lshrrev_b32 v114, 23, v86
    ds_add_rtn_u32 v87, v114, v160 offset:39936
    s_mov_b64 exec, s[60:61]
    s_cbranch_execz K2_cl_done
    v_lshrrev_b32 v116, 23, v90
    ds_add_rtn_u32 v91, v116, v160 offset:39936
    s_mov_b64 exec, s[62:63]
    s_cbranch_execz K2_cl_done
    v_lshrrev_b32 v118, 23, v94
    ds_add_rtn_u32 v95, v118, v160 offset:39936
    s_mov_b64 exec, s[64:65]
    s_cbranch_execz K2_cl_done
    v_lshrrev_b32 v120, 23, v98
    ds_add_rtn_u32 v99, v120, v160 offset:39936
    s_mov_b64 exec, s[66:67]
    s_cbranch_execz K2_cl_done
    v_lshrrev_b32 v122, 23, v102
    ds_add_rtn_u32 v103, v122, v160 offset:39936
K2_cl_done:
    s_mov_b64 exec, -1
    s_movk_i32 s38, -32
    s_mov_b32 s33, 67108864
    s_mov_b32 s34, 0
    s_mov_b64 exec, s[56:57]
    v_cmpx_gt_u32 vcc, s33, v82
    s_cbranch_execz K2_pf0
    v_alignbit_b32 v193, v82, v81, 16
    v_mad_i32_i24 v193, v193, s38, v11
    buffer_load_dword v192, v193, s[8:11], 0 offen
K2_pf0:
    s_mov_b64 exec, s[58:59]
    v_cmpx_gt_u32 vcc, s33, v86
    s_cbranch_execz K2_pf1
    v_alignbit_b32 v193, v86, v85, 16
    v_mad_i32_i24 v193, v193, s38, v11
    buffer_load_dword v192, v193, s[8:11], 0 offen
K2_pf1:
    s_mov_b64 exec, s[60:61]
    v_cmpx_gt_u32 vcc, s33, v90
    s_cbranch_execz K2_pf2
    v_alignbit_b32 v193, v90, v89, 16
    v_mad_i32_i24 v193, v193, s38, v11
    buffer_load_dword v192, v193, s[8:11], 0 offen
K2_pf2:
    s_mov_b64 exec, s[62:63]
    v_cmpx_gt_u32 vcc, s33, v94
    s_cbranch_execz K2_pf3
    v_alignbit_b32 v193, v94, v93, 16
    v_mad_i32_i24 v193, v193, s38, v11
    buffer_load_dword v192, v193, s[8:11], 0 offen
K2_pf3:
    s_mov_b64 exec, s[64:65]
    v_cmpx_gt_u32 vcc, s33, v98
    s_cbranch_execz K2_pf4
    v_alignbit_b32 v193, v98, v97, 16
    v_mad_i32_i24 v193, v193, s38, v11
    buffer_load_dword v192, v193, s[8:11], 0 offen
K2_pf4:
    s_mov_b64 exec, s[66:67]
    v_cmpx_gt_u32 vcc, s33, v102
    s_cbranch_execz K2_pf5
    v_alignbit_b32 v193, v102, v101, 16
    v_mad_i32_i24 v193, v193, s38, v11
    buffer_load_dword v192, v193, s[8:11], 0 offen
K2_pf5:
    s_mov_b64 exec, -1
    s_waitcnt lgkmcnt(0)
    s_barrier
    ds_read2_b32 v[144:145], v254 offset0:0 offset1:64
    s_waitcnt lgkmcnt(0)
    v_add3_u32 v146, v144, v145, 15
    v_lshrrev_b32 v146, 4, v146
    v_mov_b32 v147, v146
    v_sub_u32 v146, v146, v147
    v_cndmask_b32 v12, v147, v146, s[54:55]
    v_mov_b32 v148, v12
    s_nop 1
    v_add_u32_dpp v148, v148, v148 row_shr:1 row_mask:0xf bank_mask:0xf bound_ctrl:0
    s_nop 1
    v_add_u32_dpp v148, v148, v148 row_shr:2 row_mask:0xf bank_mask:0xf bound_ctrl:0
    s_nop 1
    v_add_u32_dpp v148, v148, v148 row_shr:4 row_mask:0xf bank_mask:0xf bound_ctrl:0
    s_nop 1
    v_add_u32_dpp v148, v148, v148 row_shr:8 row_mask:0xf bank_mask:0xf bound_ctrl:0
    s_nop 1
    v_add_u32_dpp v148, v148, v148 row_bcast:15 row_mask:0xa bank_mask:0xf
    s_nop 1
    v_add_u32_dpp v148, v148, v148 row_bcast:31 row_mask:0xc bank_mask:0xf
    s_nop 0
    v_readlane_b32 s33, v148, 63
    v_sub_u32 v149, v148, v12
    v_cmp_lt_u32 s[30:31], 0, v12
    v_mov_b32 v150, v149
    s_nop 1
    v_permlane32_swap_b32 v149, v150
    v_cndmask_b32 v144, 0, v144, s[54:55]
    v_sub_u32 v150, v150, v147
    v_lshl_add_u32 v149, v149, 4, v144
    v_lshl_add_u32 v150, v150, 4, v144
    v_lshlrev_b32 v147, 4, v147
    v_sub_u32 v146, v147, v144
    v_max_i32 v146, 0, v146
    v_lshl_or_b32 v147, v150, 16, v149
    v_lshlrev_b32 v254, 3, v1
    ds_write_b64 v254, v[146:147] offset:0
    s_mov_b64 exec, s[56:57]
    s_cbranch_execz K2_bl_done
    ds_read_b64 v[112:113], v112 offset:0
    s_mov_b64 exec, s[58:59]
    s_cbranch_execz K2_bl_done
    ds_read_b64 v[114:115], v114 offset:0
    s_mov_b64 exec, s[60:61]
    s_cbranch_execz K2_bl_done
    ds_read_b64 v[116:117], v116 offset:0
    s_mov_b64 exec, s[62:63]
    s_cbranch_execz K2_bl_done
    ds_read_b64 v[118:119], v118 offset:0
    s_mov_b64 exec, s[64:65]
    s_cbranch_execz K2_bl_done
    ds_read_b64 v[120:121], v120 offset:0
    s_mov_b64 exec, s[66:67]
    s_cbranch_execz K2_bl_done
    ds_read_b64 v[122:123], v122 offset:0
K2_bl_done:
    s_mov_b64 exec, -1
    s_add_u32 s27, s33, 3
    s_lshr_b32 s27, s27, 2
    s_lshl_b32 s34, s27, 2
    s_sub_u32 s34, s34, s33
    s_flbit_i32_b64 s35, s[30:31]
    s_sub_u32 s35, 63, s35
    s_and_b32 s35, s35, 63
    v_readlane_b32 s33, v12, s35
    s_add_u32 s33, s33, s34
    s_mov_b32 m0, s35
    s_nop 1
    v_writelane_b32 v12, s33, m0
    s_waitcnt lgkmcnt(0)
    s_mov_b64 exec, s[56:57]
    s_cbranch_execz K2_sl_done
    v_cmp_lt_u32 vcc, v83, v112
    s_nop 1
    v_cndmask_b32_sdwa v112, v113, v113, vcc dst_sel:DWORD dst_unused:UNUSED_PAD src0_sel:WORD_1 src1_sel:WORD_0
    v_add_u32 v112, v112, v83
    ds_write_b8 v112, v82 offset:24064
    v_lshlrev_b32 v113, 3, v112
    ds_write_b64 v113, v[80:81] offset:25856
    v_lshlrev_b32 v113, 5, v112
    v_bfi_b32 v113, v113, 0, s40
    v_and_b32 v83, s37, v82
    v_min_u32 v83, 5119488, v83
    v_or_b32 v83, v83, v113
    v_lshlrev_b32 v112, 2, v112
    ds_write_b32 v112, v83 offset:16384
    s_mov_b64 exec, s[58:59]
    s_cbranch_execz K2_sl_done
    v_cmp_lt_u32 vcc, v87, v114
    s_nop 1
    v_cndmask_b32_sdwa v114, v115, v115, vcc dst_sel:DWORD dst_unused:UNUSED_PAD src0_sel:WORD_1 src1_sel:WORD_0
    v_add_u32 v114, v114, v87
    ds_write_b8 v114, v86 offset:24064
    v_lshlrev_b32 v115, 3, v114
    ds_write_b64 v115, v[84:85] offset:25856
    v_lshlrev_b32 v115, 5, v114
    v_bfi_b32 v115, v115, 0, s40
    v_and_b32 v87, s37, v86
    v_min_u32 v87, 5119488, v87
    v_or_b32 v87, v87, v115
    v_lshlrev_b32 v114, 2, v114
    ds_write_b32 v114, v87 offset:16384
    s_mov_b64 exec, s[60:61]
    s_cbranch_execz K2_sl_done
    v_cmp_lt_u32 vcc, v91, v116
    s_nop 1
    v_cndmask_b32_sdwa v116, v117, v117, vcc dst_sel:DWORD dst_unused:UNUSED_PAD src0_sel:WORD_1 src1_sel:WORD_0
    v_add_u32 v116, v116, v91
    ds_write_b8 v116, v90 offset:24064
    v_lshlrev_b32 v117, 3, v116
    ds_write_b64 v117, v[88:89] offset:25856
    v_lshlrev_b32 v117, 5, v116
    v_bfi_b32 v117, v117, 0, s40
    v_and_b32 v91, s37, v90
    v_min_u32 v91, 5119488, v91
    v_or_b32 v91, v91, v117
    v_lshlrev_b32 v116, 2, v116
    ds_write_b32 v116, v91 offset:16384
    s_mov_b64 exec, s[62:63]
    s_cbranch_execz K2_sl_done
    v_cmp_lt_u32 vcc, v95, v118
    s_nop 1
    v_cndmask_b32_sdwa v118, v119, v119, vcc dst_sel:DWORD dst_unused:UNUSED_PAD src0_sel:WORD_1 src1_sel:WORD_0
    v_add_u32 v118, v118, v95
    ds_write_b8 v118, v94 offset:24064
    v_lshlrev_b32 v119, 3, v118
    ds_write_b64 v119, v[92:93] offset:25856
    v_lshlrev_b32 v119, 5, v118
    v_bfi_b32 v119, v119, 0, s40
    v_and_b32 v95, s37, v94
    v_min_u32 v95, 5119488, v95
    v_or_b32 v95, v95, v119
    v_lshlrev_b32 v118, 2, v118
    ds_write_b32 v118, v95 offset:16384
    s_mov_b64 exec, s[64:65]
    s_cbranch_execz K2_sl_done
    v_cmp_lt_u32 vcc, v99, v120
    s_nop 1
    v_cndmask_b32_sdwa v120, v121, v121, vcc dst_sel:DWORD dst_unused:UNUSED_PAD src0_sel:WORD_1 src1_sel:WORD_0
    v_add_u32 v120, v120, v99
    ds_write_b8 v120, v98 offset:24064
    v_lshlrev_b32 v121, 3, v120
    ds_write_b64 v121, v[96:97] offset:25856
    v_lshlrev_b32 v121, 5, v120
    v_bfi_b32 v121, v121, 0, s40
    v_and_b32 v99, s37, v98
    v_min_u32 v99, 5119488, v99
    v_or_b32 v99, v99, v121
    v_lshlrev_b32 v120, 2, v120
    ds_write_b32 v120, v99 offset:16384
    s_mov_b64 exec, s[66:67]
    s_cbranch_execz K2_sl_done
    v_cmp_lt_u32 vcc, v103, v122
    s_nop 1
    v_cndmask_b32_sdwa v122, v123, v123, vcc dst_sel:DWORD dst_unused:UNUSED_PAD src0_sel:WORD_1 src1_sel:WORD_0
    v_add_u32 v122, v122, v103
    ds_write_b8 v122, v102 offset:24064
    v_lshlrev_b32 v123, 3, v122
    ds_write_b64 v123, v[100:101] offset:25856
    v_lshlrev_b32 v123, 5, v122
    v_bfi_b32 v123, v123, 0, s40
    v_and_b32 v103, s37, v102
    v_min_u32 v103, 5119488, v103
    v_or_b32 v103, v103, v123
    v_lshlrev_b32 v122, 2, v122
    ds_write_b32 v122, v103 offset:16384
K2_sl_done:
    s_mov_b64 exec, -1
    s_waitcnt lgkmcnt(0)
    s_barrier
    s_cmp_eq_u32 s27, 0
    s_cbranch_scc1 K2_gemm
    s_movk_i32 s38, -32
    ds_read_b64 v[88:89], v8 offset:25856
    ds_read_u8 v90, v9 offset:24064
    ds_read_b64 v[226:227], v8 offset:26368
    ds_read_u8 v91, v9 offset:24128
    ds_read_b128 v[96:99], v3 offset:0
    ds_read_b128 v[100:103], v3 offset:32
    ds_read_b128 v[104:107], v3 offset:64
    ds_read_b128 v[108:111], v3 offset:96
    ds_read_b128 v[112:115], v3 offset:128
    ds_read_b128 v[116:119], v3 offset:160
    ds_read_b128 v[120:123], v3 offset:192
    ds_read_b128 v[124:127], v3 offset:224
    ds_read_b128 v[128:131], v3 offset:256
    ds_read_b128 v[132:135], v3 offset:288
    s_waitcnt lgkmcnt(10)
    v_lshrrev_b32 v228, 16, v89
    v_lshl_or_b32 v90, v90, 16, v228
    v_mad_i32_i24 v90, v90, s38, v11
    buffer_load_dwordx2 v[80:81], v90, s[8:11], 0 offen
    v_lshrrev_b32 v228, 16, v227
    v_lshl_or_b32 v91, v91, 16, v228
    v_mad_i32_i24 v91, v91, s38, v11
    s_waitcnt lgkmcnt(8)
    buffer_load_dword v144, v96, s[4:7], 0 offen
    buffer_load_dword v145, v97, s[4:7], 0 offen
    buffer_load_dword v146, v98, s[4:7], 0 offen
    buffer_load_dword v147, v99, s[4:7], 0 offen
    buffer_load_dword v148, v100, s[4:7], 0 offen
    buffer_load_dword v149, v101, s[4:7], 0 offen
    buffer_load_dword v150, v102, s[4:7], 0 offen
    buffer_load_dword v151, v103, s[4:7], 0 offen
    s_waitcnt lgkmcnt(6)
    buffer_load_dword v152, v104, s[4:7], 0 offen
    buffer_load_dword v153, v105, s[4:7], 0 offen
    buffer_load_dword v154, v106, s[4:7], 0 offen
    buffer_load_dword v155, v107, s[4:7], 0 offen
    buffer_load_dwordx2 v[224:225], v91, s[8:11], 0 offen
    buffer_load_dword v156, v108, s[4:7], 0 offen
    buffer_load_dword v157, v109, s[4:7], 0 offen
    buffer_load_dword v158, v110, s[4:7], 0 offen
    buffer_load_dword v159, v111, s[4:7], 0 offen
    s_waitcnt lgkmcnt(4)
    buffer_load_dword v160, v112, s[4:7], 0 offen
    buffer_load_dword v161, v113, s[4:7], 0 offen
    buffer_load_dword v162, v114, s[4:7], 0 offen
    buffer_load_dword v163, v115, s[4:7], 0 offen
    buffer_load_dword v164, v116, s[4:7], 0 offen
    buffer_load_dword v165, v117, s[4:7], 0 offen
    buffer_load_dword v166, v118, s[4:7], 0 offen
    buffer_load_dword v167, v119, s[4:7], 0 offen
    s_waitcnt lgkmcnt(2)
    buffer_load_dword v168, v120, s[4:7], 0 offen
    buffer_load_dword v169, v121, s[4:7], 0 offen
    buffer_load_dword v170, v122, s[4:7], 0 offen
    buffer_load_dword v171, v123, s[4:7], 0 offen
    buffer_load_dword v172, v124, s[4:7], 0 offen
    buffer_load_dword v173, v125, s[4:7], 0 offen
    buffer_load_dword v174, v126, s[4:7], 0 offen
    buffer_load_dword v175, v127, s[4:7], 0 offen
    s_waitcnt lgkmcnt(0)
    buffer_load_dword v176, v128, s[4:7], 0 offen
    buffer_load_dword v177, v129, s[4:7], 0 offen
    buffer_load_dword v178, v130, s[4:7], 0 offen
    buffer_load_dword v179, v131, s[4:7], 0 offen
    buffer_load_dword v180, v132, s[4:7], 0 offen
    buffer_load_dword v181, v133, s[4:7], 0 offen
    buffer_load_dword v182, v134, s[4:7], 0 offen
    buffer_load_dword v183, v135, s[4:7], 0 offen
    ds_read_u16 v228, v8 offset:26886
    ds_read_u8 v229, v9 offset:24192
    ds_read_b128 v[208:211], v3 offset:320
    ds_read_b128 v[212:215], v3 offset:352
    s_mov_b32 s28, 0
    v_mov_b32 v248, v10
    v_mov_b32 v243, 0
    v_mov_b32 v244, 0
    v_mov_b32 v245, 0
    v_mov_b32 v246, 0
    v_mov_b32 v96, 0
    v_mov_b32 v97, 0
    v_mov_b32 v98, 0
    v_mov_b32 v99, 0
    v_mov_b32 v100, 0
    v_mov_b32 v101, 0
    v_mov_b32 v102, 0
    v_mov_b32 v103, 0
    v_mov_b32 v104, 0
    v_mov_b32 v105, 0
    v_mov_b32 v106, 0
    v_mov_b32 v107, 0
    v_mov_b32 v108, 0
    v_mov_b32 v109, 0
    v_mov_b32 v110, 0
    v_mov_b32 v111, 0
    v_mov_b32 v112, 0
    v_mov_b32 v113, 0
    v_mov_b32 v114, 0
    v_mov_b32 v115, 0
    v_mov_b32 v116, 0
    v_mov_b32 v117, 0
    v_mov_b32 v118, 0
    v_mov_b32 v119, 0
    v_mov_b32 v120, 0
    v_mov_b32 v121, 0
    v_mov_b32 v122, 0
    v_mov_b32 v123, 0
    v_mov_b32 v124, 0
    v_mov_b32 v125, 0
    v_mov_b32 v126, 0
    v_mov_b32 v127, 0
    v_mov_b32 v128, 0
    v_mov_b32 v129, 0
    v_mov_b32 v130, 0
    v_mov_b32 v131, 0
    v_mov_b32 v132, 0
    v_mov_b32 v133, 0
    v_mov_b32 v134, 0
    v_mov_b32 v135, 0
    v_mov_b32 v136, 0
    v_mov_b32 v137, 0
    v_mov_b32 v138, 0
    v_mov_b32 v139, 0
    v_mov_b32 v140, 0
    v_mov_b32 v141, 0
    v_mov_b32 v142, 0
    v_mov_b32 v143, 0
    s_waitcnt vmcnt(41)
    v_lshlrev_b32 v230, 16, v80
    v_and_b32 v231, 0xffff0000, v80
    v_lshlrev_b32 v232, 16, v81
    v_and_b32 v233, 0xffff0000, v81
    v_lshlrev_b32 v234, 16, v88
    v_and_b32 v235, 0xffff0000, v88
    v_lshlrev_b32 v236, 16, v89
    v_mul_f32 v237, v230, v234
    v_mul_f32 v238, v231, v234
    v_mul_f32 v239, v232, v234
    v_mul_f32 v240, v233, v234
    v_cvt_pk_bf16_f32 v82, v237, v238
    v_cvt_pk_bf16_f32 v83, v239, v240
    ds_write_b128 v6, v[80:83]
    v_xor_b32 v6, 8192, v6
    v_mul_f32 v237, v230, v235
    v_mul_f32 v238, v231, v235
    v_mul_f32 v239, v232, v235
    v_mul_f32 v240, v233, v235
    v_cvt_pk_bf16_f32 v84, v237, v238
    v_cvt_pk_bf16_f32 v85, v239, v240
    v_mul_f32 v237, v230, v236
    v_mul_f32 v238, v231, v236
    v_mul_f32 v239, v232, v236
    v_mul_f32 v240, v233, v236
    v_cvt_pk_bf16_f32 v86, v237, v238
    v_cvt_pk_bf16_f32 v87, v239, v240
    ds_write_b128 v7, v[84:87]
    v_xor_b32 v7, 8192, v7
    v_mov_b32 v80, 0
    v_mov_b32 v81, 0
    v_mov_b32 v82, 0
    v_mov_b32 v83, 0
    v_mov_b32 v84, 0
    v_mov_b32 v85, 0
    v_mov_b32 v86, 0
    v_mov_b32 v87, 0
    v_mov_b32 v88, 0
    v_mov_b32 v89, 0
    v_mov_b32 v90, 0
    v_mov_b32 v91, 0
    v_mov_b32 v92, 0
    v_mov_b32 v93, 0
    v_mov_b32 v94, 0
    v_mov_b32 v95, 0
    s_waitcnt lgkmcnt(0)
    s_barrier
    ds_read_b64_tr_b16 v[192:193], v4 offset:0
    ds_read_b64_tr_b16 v[194:195], v4 offset:512
    ds_read_b64_tr_b16 v[196:197], v5 offset:0
    ds_read_b64_tr_b16 v[198:199], v5 offset:512
    s_waitcnt lgkmcnt(0)
    s_setprio 1
    s_mov_b32 s41, 0
    s_cmp_lt_u32 s2, 256
    s_cbranch_scc1 K2_loop
    s_cmp_gt_u32 s27, 6
    s_cbranch_scc0 K2_loop
    s_setprio 2
    s_movk_i32 s41, 6
K2_loop:
    s_sub_u32 s28, s28, 1
    s_cbranch_scc1 K2_f0
    ds_read_b64_tr_b16 v[200:201], v4 offset:2048
    ds_read_b64_tr_b16 v[202:203], v4 offset:2560
    ds_read_b64_tr_b16 v[204:205], v5 offset:2048
    ds_read_b64_tr_b16 v[206:207], v5 offset:2560
    s_waitcnt lgkmcnt(5)
    s_waitcnt vmcnt(28)
    v_smfmac_f32_32x32x32_bf16 v[80:95], v[192:195], v[144:151], v249
    buffer_load_dword v184, v208, s[4:7], 0 offen
    buffer_load_dword v185, v209, s[4:7], 0 offen
    v_lshlrev_b32 v230, 16, v224
    v_and_b32 v231, 0xffff0000, v224
    v_lshlrev_b32 v232, 16, v225
    v_and_b32 v233, 0xffff0000, v225
    v_smfmac_f32_32x32x32_bf16 v[96:111], v[192:195], v[144:151], v249 abid:1
    buffer_load_dword v186, v210, s[4:7], 0 offen
    buffer_load_dword v187, v211, s[4:7], 0 offen
    v_mov_b32 v216, v224
    v_mov_b32 v217, v225
    v_lshl_or_b32 v229, v229, 16, v228
    v_mad_i32_i24 v229, v229, s38, v11
    buffer_load_dwordx2 v[224:225], v229, s[8:11], 0 offen
    ds_read_b128 v[208:211], v3 offset:384
    s_waitcnt lgkmcnt(5)
    v_smfmac_f32_32x32x32_bf16 v[112:127], v[196:199], v[144:151], v249
    buffer_load_dword v188, v212, s[4:7], 0 offen
    buffer_load_dword v189, v213, s[4:7], 0 offen
    v_lshlrev_b32 v234, 16, v226
    v_and_b32 v235, 0xffff0000, v226
    v_lshlrev_b32 v236, 16, v227
    v_smfmac_f32_32x32x32_bf16 v[128:143], v[196:199], v[144:151], v249 abid:1
    buffer_load_dword v190, v214, s[4:7], 0 offen
    buffer_load_dword v191, v215, s[4:7], 0 offen
    v_mul_f32 v237, v230, v234
    v_mul_f32 v238, v231, v234
    v_mul_f32 v239, v232, v234
    ds_read_b128 v[212:215], v3 offset:416
K2_j0:
    s_sub_u32 s28, s28, 1
    s_cbranch_scc1 K2_f1
    ds_read_b64_tr_b16 v[192:193], v4 offset:4096
    ds_read_b64_tr_b16 v[194:195], v4 offset:4608
    ds_read_b64_tr_b16 v[196:197], v5 offset:4096
    ds_read_b64_tr_b16 v[198:199], v5 offset:4608
    s_waitcnt lgkmcnt(5)
    s_waitcnt vmcnt(33)
    v_smfmac_f32_32x32x32_bf16 v[80:95], v[200:203], v[152:159], v249
    buffer_load_dword v144, v208, s[4:7], 0 offen
    buffer_load_dword v145, v209, s[4:7], 0 offen
    v_mul_f32 v240, v233, v234
    v_cvt_pk_bf16_f32 v218, v237, v238
    v_smfmac_f32_32x32x32_bf16 v[96:111], v[200:203], v[152:159], v249 abid:1
    buffer_load_dword v146, v210, s[4:7], 0 offen
    buffer_load_dword v147, v211, s[4:7], 0 offen
    v_cvt_pk_bf16_f32 v219, v239, v240
    ds_write_b128 v6, v[216:219]
    v_xor_b32 v6, 8192, v6
    ds_read_b128 v[208:211], v3 offset:448
    s_waitcnt lgkmcnt(6)
    v_smfmac_f32_32x32x32_bf16 v[112:127], v[204:207], v[152:159], v249
    buffer_load_dword v148, v212, s[4:7], 0 offen
    buffer_load_dword v149, v213, s[4:7], 0 offen
    v_mul_f32 v237, v230, v235
    v_mul_f32 v238, v231, v235
    v_smfmac_f32_32x32x32_bf16 v[128:143], v[204:207], v[152:159], v249 abid:1
    buffer_load_dword v150, v214, s[4:7], 0 offen
    buffer_load_dword v151, v215, s[4:7], 0 offen
    v_mul_f32 v239, v232, v235
    v_mul_f32 v240, v233, v235
    v_cvt_pk_bf16_f32 v220, v237, v238
    ds_read_b128 v[212:215], v3 offset:480
K2_j1:
    s_sub_u32 s28, s28, 1
    s_cbranch_scc1 K2_f2
    ds_read_b64_tr_b16 v[200:201], v4 offset:6144
    ds_read_b64_tr_b16 v[202:203], v4 offset:6656
    ds_read_b64_tr_b16 v[204:205], v5 offset:6144
    ds_read_b64_tr_b16 v[206:207], v5 offset:6656
    s_waitcnt lgkmcnt(5)
    s_waitcnt vmcnt(33)
    v_smfmac_f32_32x32x32_bf16 v[80:95], v[192:195], v[160:167], v249
    buffer_load_dword v152, v208, s[4:7], 0 offen
    buffer_load_dword v153, v209, s[4:7], 0 offen
    v_cvt_pk_bf16_f32 v221, v239, v240
    v_mul_f32 v237, v230, v236
    v_smfmac_f32_32x32x32_bf16 v[96:111], v[192:195], v[160:167], v249 abid:1
    buffer_load_dword v154, v210, s[4:7], 0 offen
    buffer_load_dword v155, v211, s[4:7], 0 offen
    v_mul_f32 v238, v231, v236
    v_mul_f32 v239, v232, v236
    v_mul_f32 v240, v233, v236
    ds_read_b128 v[208:211], v3 offset:512
    s_waitcnt lgkmcnt(5)
    v_smfmac_f32_32x32x32_bf16 v[112:127], v[196:199], v[160:167], v249
    buffer_load_dword v156, v212, s[4:7], 0 offen
    buffer_load_dword v157, v213, s[4:7], 0 offen
    v_cvt_pk_bf16_f32 v222, v237, v238
    v_cvt_pk_bf16_f32 v223, v239, v240
    v_smfmac_f32_32x32x32_bf16 v[128:143], v[196:199], v[160:167], v249 abid:1
    buffer_load_dword v158, v214, s[4:7], 0 offen
    buffer_load_dword v159, v215, s[4:7], 0 offen
    ds_write_b128 v7, v[220:223]
    v_xor_b32 v7, 8192, v7
    ds_read_b128 v[212:215], v3 offset:544
K2_j2:
    s_sub_u32 s28, s28, 1
    s_cbranch_scc1 K2_f3
    s_waitcnt lgkmcnt(1)
    s_waitcnt vmcnt(33)
    v_smfmac_f32_32x32x32_bf16 v[80:95], v[200:203], v[168:175], v249
    buffer_load_dword v160, v208, s[4:7], 0 offen
    buffer_load_dword v161, v209, s[4:7], 0 offen
    v_smfmac_f32_32x32x32_bf16 v[96:111], v[200:203], v[168:175], v249 abid:1
    buffer_load_dword v162, v210, s[4:7], 0 offen
    buffer_load_dword v163, v211, s[4:7], 0 offen
    s_waitcnt lgkmcnt(0)
    s_barrier
    v_xor_b32 v4, 8192, v4
    v_xor_b32 v5, 8192, v5
    ds_read_b64_tr_b16 v[192:193], v4 offset:0
    ds_read_b64_tr_b16 v[194:195], v4 offset:512
    ds_read_b64_tr_b16 v[196:197], v5 offset:0
    ds_read_b64_tr_b16 v[198:199], v5 offset:512
    ds_read_b128 v[208:211], v3 offset:576
    s_waitcnt lgkmcnt(5)
    v_smfmac_f32_32x32x32_bf16 v[112:127], v[204:207], v[168:175], v249
    buffer_load_dword v164, v212, s[4:7], 0 offen
    buffer_load_dword v165, v213, s[4:7], 0 offen
    ds_read_b64 v[226:227], v8 offset:26880
    ds_read_u16 v228, v8 offset:27398
    ds_read_u8 v229, v9 offset:24256
    v_smfmac_f32_32x32x32_bf16 v[128:143], v[204:207], v[168:175], v249 abid:1
    buffer_load_dword v166, v214, s[4:7], 0 offen
    buffer_load_dword v167, v215, s[4:7], 0 offen
    ds_read_b128 v[212:215], v3 offset:608
K2_j3:
    s_sub_u32 s27, s27, 1
    s_cmp_eq_u32 s27, s41
    s_cbranch_scc1 DP_e3
DP_r3:
    s_sub_u32 s28, s28, 1
    s_cbranch_scc1 K2_f4
    ds_read_b64_tr_b16 v[200:201], v4 offset:2048
    ds_read_b64_tr_b16 v[202:203], v4 offset:2560
    ds_read_b64_tr_b16 v[204:205], v5 offset:2048
    ds_read_b64_tr_b16 v[206:207], v5 offset:2560
    s_waitcnt lgkmcnt(5)
    s_waitcnt vmcnt(28)
    v_smfmac_f32_32x32x32_bf16 v[80:95], v[192:195], v[176:183], v249
    buffer_load_dword v168, v208, s[4:7], 0 offen
    buffer_load_dword v169, v209, s[4:7], 0 offen
    v_lshlrev_b32 v230, 16, v224
    v_and_b32 v231, 0xffff0000, v224
    v_lshlrev_b32 v232, 16, v225
    v_and_b32 v233, 0xffff0000, v225
    v_smfmac_f32_32x32x32_bf16 v[96:111], v[192:195], v[176:183], v249 abid:1
    buffer_load_dword v170, v210, s[4:7], 0 offen
    buffer_load_dword v171, v211, s[4:7], 0 offen
    v_mov_b32 v216, v224
    v_mov_b32 v217, v225
    v_lshl_or_b32 v229, v229, 16, v228
    v_mad_i32_i24 v229, v229, s38, v11
    buffer_load_dwordx2 v[224:225], v229, s[8:11], 0 offen
    ds_read_b128 v[208:211], v3 offset:640
    s_waitcnt lgkmcnt(5)
    v_smfmac_f32_32x32x32_bf16 v[112:127], v[196:199], v[176:183], v249
    buffer_load_dword v172, v212, s[4:7], 0 offen
    buffer_load_dword v173, v213, s[4:7], 0 offen
    v_lshlrev_b32 v234, 16, v226
    v_and_b32 v235, 0xffff0000, v226
    v_lshlrev_b32 v236, 16, v227
    v_smfmac_f32_32x32x32_bf16 v[128:143], v[196:199], v[176:183], v249 abid:1
    buffer_load_dword v174, v214, s[4:7], 0 offen
    buffer_load_dword v175, v215, s[4:7], 0 offen
    v_mul_f32 v237, v230, v234
    v_mul_f32 v238, v231, v234
    v_mul_f32 v239, v232, v234
    ds_read_b128 v[212:215], v3 offset:672
K2_j4:
    s_sub_u32 s28, s28, 1
    s_cbranch_scc1 K2_f5
    ds_read_b64_tr_b16 v[192:193], v4 offset:4096
    ds_read_b64_tr_b16 v[194:195], v4 offset:4608
    ds_read_b64_tr_b16 v[196:197], v5 offset:4096
    ds_read_b64_tr_b16 v[198:199], v5 offset:4608
    s_waitcnt lgkmcnt(5)
    s_waitcnt vmcnt(33)
    v_smfmac_f32_32x32x32_bf16 v[80:95], v[200:203], v[184:191], v249
    buffer_load_dword v176, v208, s[4:7], 0 offen
    buffer_load_dword v177, v209, s[4:7], 0 offen
    v_mul_f32 v240, v233, v234
    v_cvt_pk_bf16_f32 v218, v237, v238
    v_smfmac_f32_32x32x32_bf16 v[96:111], v[200:203], v[184:191], v249 abid:1
    buffer_load_dword v178, v210, s[4:7], 0 offen
    buffer_load_dword v179, v211, s[4:7], 0 offen
    v_cvt_pk_bf16_f32 v219, v239, v240
    ds_write_b128 v6, v[216:219]
    v_xor_b32 v6, 8192, v6
    ds_read_b128 v[208:211], v3 offset:704
    s_waitcnt lgkmcnt(6)
    v_smfmac_f32_32x32x32_bf16 v[112:127], v[204:207], v[184:191], v249
    buffer_load_dword v180, v212, s[4:7], 0 offen
    buffer_load_dword v181, v213, s[4:7], 0 offen
    v_mul_f32 v237, v230, v235
    v_mul_f32 v238, v231, v235
    v_smfmac_f32_32x32x32_bf16 v[128:143], v[204:207], v[184:191], v249 abid:1
    buffer_load_dword v182, v214, s[4:7], 0 offen
    buffer_load_dword v183, v215, s[4:7], 0 offen
    v_mul_f32 v239, v232, v235
    v_mul_f32 v240, v233, v235
    v_cvt_pk_bf16_f32 v220, v237, v238
    ds_read_b128 v[212:215], v3 offset:736
K2_j5:
    s_sub_u32 s28, s28, 1
    s_cbranch_scc1 K2_f6
    ds_read_b64_tr_b16 v[200:201], v4 offset:6144
    ds_read_b64_tr_b16 v[202:203], v4 offset:6656
    ds_read_b64_tr_b16 v[204:205], v5 offset:6144
    ds_read_b64_tr_b16 v[206:207], v5 offset:6656
    s_waitcnt lgkmcnt(5)
    s_waitcnt vmcnt(33)
    v_smfmac_f32_32x32x32_bf16 v[80:95], v[192:195], v[144:151], v249
    buffer_load_dword v184, v208, s[4:7], 0 offen
    buffer_load_dword v185, v209, s[4:7], 0 offen
    v_cvt_pk_bf16_f32 v221, v239, v240
    v_mul_f32 v237, v230, v236
    v_smfmac_f32_32x32x32_bf16 v[96:111], v[192:195], v[144:151], v249 abid:1
    buffer_load_dword v186, v210, s[4:7], 0 offen
    buffer_load_dword v187, v211, s[4:7], 0 offen
    v_mul_f32 v238, v231, v236
    v_mul_f32 v239, v232, v236
    v_mul_f32 v240, v233, v236
    ds_read_b128 v[208:211], v3 offset:768
    s_waitcnt lgkmcnt(5)
    v_smfmac_f32_32x32x32_bf16 v[112:127], v[196:199], v[144:151], v249
    buffer_load_dword v188, v212, s[4:7], 0 offen
    buffer_load_dword v189, v213, s[4:7], 0 offen
    v_cvt_pk_bf16_f32 v222, v237, v238
    v_cvt_pk_bf16_f32 v223, v239, v240
    v_smfmac_f32_32x32x32_bf16 v[128:143], v[196:199], v[144:151], v249 abid:1
    buffer_load_dword v190, v214, s[4:7], 0 offen
    buffer_load_dword v191, v215, s[4:7], 0 offen
    ds_write_b128 v7, v[220:223]
    v_xor_b32 v7, 8192, v7
    ds_read_b128 v[212:215], v3 offset:800
K2_j6:
    s_sub_u32 s28, s28, 1
    s_cbranch_scc1 K2_f7
    s_waitcnt lgkmcnt(1)
    s_waitcnt vmcnt(33)
    v_smfmac_f32_32x32x32_bf16 v[80:95], v[200:203], v[152:159], v249
    buffer_load_dword v144, v208, s[4:7], 0 offen
    buffer_load_dword v145, v209, s[4:7], 0 offen
    v_smfmac_f32_32x32x32_bf16 v[96:111], v[200:203], v[152:159], v249 abid:1
    buffer_load_dword v146, v210, s[4:7], 0 offen
    buffer_load_dword v147, v211, s[4:7], 0 offen
    s_waitcnt lgkmcnt(0)
    s_barrier
    v_xor_b32 v4, 8192, v4
    v_xor_b32 v5, 8192, v5
    ds_read_b64_tr_b16 v[192:193], v4 offset:0
    ds_read_b64_tr_b16 v[194:195], v4 offset:512
    ds_read_b64_tr_b16 v[196:197], v5 offset:0
    ds_read_b64_tr_b16 v[198:199], v5 offset:512
    ds_read_b128 v[208:211], v3 offset:832
    s_waitcnt lgkmcnt(5)
    v_smfmac_f32_32x32x32_bf16 v[112:127], v[204:207], v[152:159], v249
    buffer_load_dword v148, v212, s[4:7], 0 offen
    buffer_load_dword v149, v213, s[4:7], 0 offen
    ds_read_b64 v[226:227], v8 offset:27392
    ds_read_u16 v228, v8 offset:27910
    ds_read_u8 v229, v9 offset:24320
    v_smfmac_f32_32x32x32_bf16 v[128:143], v[204:207], v[152:159], v249 abid:1
    buffer_load_dword v150, v214, s[4:7], 0 offen
    buffer_load_dword v151, v215, s[4:7], 0 offen
    ds_read_b128 v[212:215], v3 offset:864
K2_j7:
    s_sub_u32 s27, s27, 1
    s_cmp_eq_u32 s27, s41
    s_cbranch_scc1 DP_e7
DP_r7:
    s_sub_u32 s28, s28, 1
    s_cbranch_scc1 K2_f8
    ds_read_b64_tr_b16 v[200:201], v4 offset:2048
    ds_read_b64_tr_b16 v[202:203], v4 offset:2560
    ds_read_b64_tr_b16 v[204:205], v5 offset:2048
    ds_read_b64_tr_b16 v[206:207], v5 offset:2560
    s_waitcnt lgkmcnt(5)
    s_waitcnt vmcnt(28)
    v_smfmac_f32_32x32x32_bf16 v[80:95], v[192:195], v[160:167], v249
    buffer_load_dword v152, v208, s[4:7], 0 offen
    buffer_load_dword v153, v209, s[4:7], 0 offen
    v_lshlrev_b32 v230, 16, v224
    v_and_b32 v231, 0xffff0000, v224
    v_lshlrev_b32 v232, 16, v225
    v_and_b32 v233, 0xffff0000, v225
    v_smfmac_f32_32x32x32_bf16 v[96:111], v[192:195], v[160:167], v249 abid:1
    buffer_load_dword v154, v210, s[4:7], 0 offen
    buffer_load_dword v155, v211, s[4:7], 0 offen
    v_mov_b32 v216, v224
    v_mov_b32 v217, v225
    v_lshl_or_b32 v229, v229, 16, v228
    v_mad_i32_i24 v229, v229, s38, v11
    buffer_load_dwordx2 v[224:225], v229, s[8:11], 0 offen
    ds_read_b128 v[208:211], v3 offset:896
    s_waitcnt lgkmcnt(5)
    v_smfmac_f32_32x32x32_bf16 v[112:127], v[196:199], v[160:167], v249
    buffer_load_dword v156, v212, s[4:7], 0 offen
    buffer_load_dword v157, v213, s[4:7], 0 offen
    v_lshlrev_b32 v234, 16, v226
    v_and_b32 v235, 0xffff0000, v226
    v_lshlrev_b32 v236, 16, v227
    v_smfmac_f32_32x32x32_bf16 v[128:143], v[196:199], v[160:167], v249 abid:1
    buffer_load_dword v158, v214, s[4:7], 0 offen
    buffer_load_dword v159, v215, s[4:7], 0 offen
    v_mul_f32 v237, v230, v234
    v_mul_f32 v238, v231, v234
    v_mul_f32 v239, v232, v234
    ds_read_b128 v[212:215], v3 offset:928
K2_j8:
    s_sub_u32 s28, s28, 1
    s_cbranch_scc1 K2_f9
    ds_read_b64_tr_b16 v[192:193], v4 offset:4096
    ds_read_b64_tr_b16 v[194:195], v4 offset:4608
    ds_read_b64_tr_b16 v[196:197], v5 offset:4096
    ds_read_b64_tr_b16 v[198:199], v5 offset:4608
    s_waitcnt lgkmcnt(5)
    s_waitcnt vmcnt(33)
    v_smfmac_f32_32x32x32_bf16 v[80:95], v[200:203], v[168:175], v249
    buffer_load_dword v160, v208, s[4:7], 0 offen
    buffer_load_dword v161, v209, s[4:7], 0 offen
    v_mul_f32 v240, v233, v234
    v_cvt_pk_bf16_f32 v218, v237, v238
    v_smfmac_f32_32x32x32_bf16 v[96:111], v[200:203], v[168:175], v249 abid:1
    buffer_load_dword v162, v210, s[4:7], 0 offen
    buffer_load_dword v163, v211, s[4:7], 0 offen
    v_cvt_pk_bf16_f32 v219, v239, v240
    ds_write_b128 v6, v[216:219]
    v_xor_b32 v6, 8192, v6
    ds_read_b128 v[208:211], v3 offset:960
    s_waitcnt lgkmcnt(6)
    v_smfmac_f32_32x32x32_bf16 v[112:127], v[204:207], v[168:175], v249
    buffer_load_dword v164, v212, s[4:7], 0 offen
    buffer_load_dword v165, v213, s[4:7], 0 offen
    v_mul_f32 v237, v230, v235
    v_mul_f32 v238, v231, v235
    v_smfmac_f32_32x32x32_bf16 v[128:143], v[204:207], v[168:175], v249 abid:1
    buffer_load_dword v166, v214, s[4:7], 0 offen
    buffer_load_dword v167, v215, s[4:7], 0 offen
    v_mul_f32 v239, v232, v235
    v_mul_f32 v240, v233, v235
    v_cvt_pk_bf16_f32 v220, v237, v238
    ds_read_b128 v[212:215], v3 offset:992
K2_j9:
    s_sub_u32 s28, s28, 1
    s_cbranch_scc1 K2_f10
    ds_read_b64_tr_b16 v[200:201], v4 offset:6144
    ds_read_b64_tr_b16 v[202:203], v4 offset:6656
    ds_read_b64_tr_b16 v[204:205], v5 offset:6144
    ds_read_b64_tr_b16 v[206:207], v5 offset:6656
    s_waitcnt lgkmcnt(5)
    s_waitcnt vmcnt(33)
    v_smfmac_f32_32x32x32_bf16 v[80:95], v[192:195], v[176:183], v249
    buffer_load_dword v168, v208, s[4:7], 0 offen
    buffer_load_dword v169, v209, s[4:7], 0 offen
    v_cvt_pk_bf16_f32 v221, v239, v240
    v_mul_f32 v237, v230, v236
    v_smfmac_f32_32x32x32_bf16 v[96:111], v[192:195], v[176:183], v249 abid:1
    buffer_load_dword v170, v210, s[4:7], 0 offen
    buffer_load_dword v171, v211, s[4:7], 0 offen
    v_mul_f32 v238, v231, v236
    v_mul_f32 v239, v232, v236
    v_mul_f32 v240, v233, v236
    ds_read_b128 v[208:211], v3 offset:1024
    s_waitcnt lgkmcnt(5)
    v_smfmac_f32_32x32x32_bf16 v[112:127], v[196:199], v[176:183], v249
    buffer_load_dword v172, v212, s[4:7], 0 offen
    buffer_load_dword v173, v213, s[4:7], 0 offen
    v_cvt_pk_bf16_f32 v222, v237, v238
    v_cvt_pk_bf16_f32 v223, v239, v240
    v_smfmac_f32_32x32x32_bf16 v[128:143], v[196:199], v[176:183], v249 abid:1
    buffer_load_dword v174, v214, s[4:7], 0 offen
    buffer_load_dword v175, v215, s[4:7], 0 offen
    ds_write_b128 v7, v[220:223]
    v_xor_b32 v7, 8192, v7
    ds_read_b128 v[212:215], v3 offset:1056
K2_j10:
    s_sub_u32 s28, s28, 1
    s_cbranch_scc1 K2_f11
    s_waitcnt lgkmcnt(1)
    s_waitcnt vmcnt(33)
    v_smfmac_f32_32x32x32_bf16 v[80:95], v[200:203], v[184:191], v249
    buffer_load_dword v176, v208, s[4:7], 0 offen
    buffer_load_dword v177, v209, s[4:7], 0 offen
    v_add_u32 v3, 768, v3
    v_add_u32 v8, 1536, v8
    v_add_u32 v9, 192, v9
    v_smfmac_f32_32x32x32_bf16 v[96:111], v[200:203], v[184:191], v249 abid:1
    buffer_load_dword v178, v210, s[4:7], 0 offen
    buffer_load_dword v179, v211, s[4:7], 0 offen
    s_waitcnt lgkmcnt(0)
    s_barrier
    v_xor_b32 v4, 8192, v4
    v_xor_b32 v5, 8192, v5
    ds_read_b64_tr_b16 v[192:193], v4 offset:0
    ds_read_b64_tr_b16 v[194:195], v4 offset:512
    ds_read_b64_tr_b16 v[196:197], v5 offset:0
    ds_read_b64_tr_b16 v[198:199], v5 offset:512
    ds_read_b128 v[208:211], v3 offset:320
    s_waitcnt lgkmcnt(5)
    v_smfmac_f32_32x32x32_bf16 v[112:127], v[204:207], v[184:191], v249
    buffer_load_dword v180, v212, s[4:7], 0 offen
    buffer_load_dword v181, v213, s[4:7], 0 offen
    ds_read_b64 v[226:227], v8 offset:26368
    ds_read_u16 v228, v8 offset:26886
    ds_read_u8 v229, v9 offset:24192
    v_smfmac_f32_32x32x32_bf16 v[128:143], v[204:207], v[184:191], v249 abid:1
    buffer_load_dword v182, v214, s[4:7], 0 offen
    buffer_load_dword v183, v215, s[4:7], 0 offen
    ds_read_b128 v[212:215], v3 offset:352
K2_j11:
    s_sub_u32 s27, s27, 1
    s_cmp_eq_u32 s27, s41
    s_cbranch_scc0 K2_loop
DP_e11:
    s_cmp_eq_u32 s41, 0
    s_cbranch_scc1 K2_tail
    s_setprio 0
    s_movk_i32 s41, 0
    s_branch K2_loop
DP_e7:
    s_cmp_eq_u32 s41, 0
    s_cbranch_scc1 K2_tail
    s_setprio 0
    s_movk_i32 s41, 0
    s_branch DP_r7
DP_e3:
    s_cmp_eq_u32 s41, 0
    s_cbranch_scc1 K2_tail
    s_setprio 0
    s_movk_i32 s41, 0
    s_branch DP_r3
K2_f0:
    ds_read_b64_tr_b16 v[200:201], v4 offset:2048
    ds_read_b64_tr_b16 v[202:203], v4 offset:2560
    ds_read_b64_tr_b16 v[204:205], v5 offset:2048
    ds_read_b64_tr_b16 v[206:207], v5 offset:2560
    s_waitcnt lgkmcnt(5)
    s_ff1_i32_b64 s33, s[30:31]
    s_bitset0_b64 s[30:31], s33
    v_readlane_b32 s28, v12, s33
    s_and_b32 s33, s33, 31
    s_mul_i32 s29, s33, 2064
    v_fma_f32 v241, v80, v16, -v243
    v_fmac_f32 v241, v81, v17
    v_fmac_f32 v241, v82, v18
    v_fmac_f32 v241, v83, v19
    v_fmac_f32 v241, v84, v20
    v_fmac_f32 v241, v85, v21
    v_fmac_f32 v241, v86, v22
    v_fmac_f32 v241, v87, v23
    v_fmac_f32 v241, v88, v24
    v_fmac_f32 v241, v89, v25
    v_fmac_f32 v241, v90, v26
    v_fmac_f32 v241, v91, v27
    v_fmac_f32 v241, v92, v28
    v_fmac_f32 v241, v93, v29
    v_fmac_f32 v241, v94, v30
    v_fmac_f32 v241, v95, v31
    s_sub_u32 s28, s28, 1
    s_waitcnt vmcnt(28)
    v_smfmac_f32_32x32x32_bf16 v[80:95], v[192:195], v[144:151], v249
    buffer_load_dword v184, v208, s[4:7], 0 offen
    buffer_load_dword v185, v209, s[4:7], 0 offen
    v_add_f32 v243, v243, v241
    v_lshlrev_b32 v230, 16, v224
    v_and_b32 v231, 0xffff0000, v224
    v_lshlrev_b32 v232, 16, v225
    v_and_b32 v233, 0xffff0000, v225
    v_fma_f32 v242, v96, v32, -v244
    v_fmac_f32 v242, v97, v33
    v_fmac_f32 v242, v98, v34
    v_fmac_f32 v242, v99, v35
    v_fmac_f32 v242, v100, v36
    v_fmac_f32 v242, v101, v37
    v_fmac_f32 v242, v102, v38
    v_fmac_f32 v242, v103, v39
    v_fmac_f32 v242, v104, v40
    v_fmac_f32 v242, v105, v41
    v_fmac_f32 v242, v106, v42
    v_fmac_f32 v242, v107, v43
    v_fmac_f32 v242, v108, v44
    v_fmac_f32 v242, v109, v45
    v_fmac_f32 v242, v110, v46
    v_fmac_f32 v242, v111, v47
    v_smfmac_f32_32x32x32_bf16 v[96:111], v[192:195], v[144:151], v249 abid:1
    buffer_load_dword v186, v210, s[4:7], 0 offen
    buffer_load_dword v187, v211, s[4:7], 0 offen
    v_add_f32 v244, v244, v242
    v_cvt_pk_bf16_f32 v241, v241, v242
    ds_write_b32 v248, v241 offset:0
    v_mov_b32 v216, v224
    v_mov_b32 v217, v225
    v_lshl_or_b32 v229, v229, 16, v228
    v_mad_i32_i24 v229, v229, s38, v11
    buffer_load_dwordx2 v[224:225], v229, s[8:11], 0 offen
    ds_read_b128 v[208:211], v3 offset:384
    v_fma_f32 v241, v112, v48, -v245
    v_fmac_f32 v241, v113, v49
    v_fmac_f32 v241, v114, v50
    v_fmac_f32 v241, v115, v51
    v_fmac_f32 v241, v116, v52
    v_fmac_f32 v241, v117, v53
    v_fmac_f32 v241, v118, v54
    v_fmac_f32 v241, v119, v55
    v_fmac_f32 v241, v120, v56
    v_fmac_f32 v241, v121, v57
    v_fmac_f32 v241, v122, v58
    v_fmac_f32 v241, v123, v59
    v_fmac_f32 v241, v124, v60
    v_fmac_f32 v241, v125, v61
    v_fmac_f32 v241, v126, v62
    v_fmac_f32 v241, v127, v63
    s_waitcnt lgkmcnt(6)
    v_smfmac_f32_32x32x32_bf16 v[112:127], v[196:199], v[144:151], v249
    buffer_load_dword v188, v212, s[4:7], 0 offen
    buffer_load_dword v189, v213, s[4:7], 0 offen
    v_add_f32 v245, v245, v241
    v_lshlrev_b32 v234, 16, v226
    v_and_b32 v235, 0xffff0000, v226
    v_lshlrev_b32 v236, 16, v227
    v_fma_f32 v242, v128, v64, -v246
    v_fmac_f32 v242, v129, v65
    v_fmac_f32 v242, v130, v66
    v_fmac_f32 v242, v131, v67
    v_fmac_f32 v242, v132, v68
    v_fmac_f32 v242, v133, v69
    v_fmac_f32 v242, v134, v70
    v_fmac_f32 v242, v135, v71
    v_fmac_f32 v242, v136, v72
    v_fmac_f32 v242, v137, v73
    v_fmac_f32 v242, v138, v74
    v_fmac_f32 v242, v139, v75
    v_fmac_f32 v242, v140, v76
    v_fmac_f32 v242, v141, v77
    v_fmac_f32 v242, v142, v78
    v_fmac_f32 v242, v143, v79
    v_smfmac_f32_32x32x32_bf16 v[128:143], v[196:199], v[144:151], v249 abid:1
    buffer_load_dword v190, v214, s[4:7], 0 offen
    buffer_load_dword v191, v215, s[4:7], 0 offen
    v_add_f32 v246, v246, v242
    v_cvt_pk_bf16_f32 v241, v241, v242
    ds_write_b32 v248, v241 offset:1024
    v_mul_f32 v237, v230, v234
    v_mul_f32 v238, v231, v234
    v_mul_f32 v239, v232, v234
    v_add_u32 v248, s29, v10
    ds_read_b128 v[212:215], v3 offset:416
    s_branch K2_j0
K2_f1:
    ds_read_b64_tr_b16 v[192:193], v4 offset:4096
    ds_read_b64_tr_b16 v[194:195], v4 offset:4608
    ds_read_b64_tr_b16 v[196:197], v5 offset:4096
    ds_read_b64_tr_b16 v[198:199], v5 offset:4608
    s_waitcnt lgkmcnt(5)
    s_ff1_i32_b64 s33, s[30:31]
    s_bitset0_b64 s[30:31], s33
    v_readlane_b32 s28, v12, s33
    s_and_b32 s33, s33, 31
    s_mul_i32 s29, s33, 2064
    v_fma_f32 v241, v80, v16, -v243
    v_fmac_f32 v241, v81, v17
    v_fmac_f32 v241, v82, v18
    v_fmac_f32 v241, v83, v19
    v_fmac_f32 v241, v84, v20
    v_fmac_f32 v241, v85, v21
    v_fmac_f32 v241, v86, v22
    v_fmac_f32 v241, v87, v23
    v_fmac_f32 v241, v88, v24
    v_fmac_f32 v241, v89, v25
    v_fmac_f32 v241, v90, v26
    v_fmac_f32 v241, v91, v27
    v_fmac_f32 v241, v92, v28
    v_fmac_f32 v241, v93, v29
    v_fmac_f32 v241, v94, v30
    v_fmac_f32 v241, v95, v31
    s_sub_u32 s28, s28, 1
    s_waitcnt vmcnt(33)
    v_smfmac_f32_32x32x32_bf16 v[80:95], v[200:203], v[152:159], v249
    buffer_load_dword v144, v208, s[4:7], 0 offen
    buffer_load_dword v145, v209, s[4:7], 0 offen
    v_add_f32 v243, v243, v241
    v_mul_f32 v240, v233, v234
    v_cvt_pk_bf16_f32 v218, v237, v238
    v_fma_f32 v242, v96, v32, -v244
    v_fmac_f32 v242, v97, v33
    v_fmac_f32 v242, v98, v34
    v_fmac_f32 v242, v99, v35
    v_fmac_f32 v242, v100, v36
    v_fmac_f32 v242, v101, v37
    v_fmac_f32 v242, v102, v38
    v_fmac_f32 v242, v103, v39
    v_fmac_f32 v242, v104, v40
    v_fmac_f32 v242, v105, v41
    v_fmac_f32 v242, v106, v42
    v_fmac_f32 v242, v107, v43
    v_fmac_f32 v242, v108, v44
    v_fmac_f32 v242, v109, v45
    v_fmac_f32 v242, v110, v46
    v_fmac_f32 v242, v111, v47
    v_smfmac_f32_32x32x32_bf16 v[96:111], v[200:203], v[152:159], v249 abid:1
    buffer_load_dword v146, v210, s[4:7], 0 offen
    buffer_load_dword v147, v211, s[4:7], 0 offen
    v_add_f32 v244, v244, v242
    v_cvt_pk_bf16_f32 v241, v241, v242
    ds_write_b32 v248, v241 offset:0
    v_cvt_pk_bf16_f32 v219, v239, v240
    ds_write_b128 v6, v[216:219]
    v_xor_b32 v6, 8192, v6
    ds_read_b128 v[208:211], v3 offset:448
    v_fma_f32 v241, v112, v48, -v245
    v_fmac_f32 v241, v113, v49
    v_fmac_f32 v241, v114, v50
    v_fmac_f32 v241, v115, v51
    v_fmac_f32 v241, v116, v52
    v_fmac_f32 v241, v117, v53
    v_fmac_f32 v241, v118, v54
    v_fmac_f32 v241, v119, v55
    v_fmac_f32 v241, v120, v56
    v_fmac_f32 v241, v121, v57
    v_fmac_f32 v241, v122, v58
    v_fmac_f32 v241, v123, v59
    v_fmac_f32 v241, v124, v60
    v_fmac_f32 v241, v125, v61
    v_fmac_f32 v241, v126, v62
    v_fmac_f32 v241, v127, v63
    s_waitcnt lgkmcnt(7)
    v_smfmac_f32_32x32x32_bf16 v[112:127], v[204:207], v[152:159], v249
    buffer_load_dword v148, v212, s[4:7], 0 offen
    buffer_load_dword v149, v213, s[4:7], 0 offen
    v_add_f32 v245, v245, v241
    v_mul_f32 v237, v230, v235
    v_mul_f32 v238, v231, v235
    v_fma_f32 v242, v128, v64, -v246
    v_fmac_f32 v242, v129, v65
    v_fmac_f32 v242, v130, v66
    v_fmac_f32 v242, v131, v67
    v_fmac_f32 v242, v132, v68
    v_fmac_f32 v242, v133, v69
    v_fmac_f32 v242, v134, v70
    v_fmac_f32 v242, v135, v71
    v_fmac_f32 v242, v136, v72
    v_fmac_f32 v242, v137, v73
    v_fmac_f32 v242, v138, v74
    v_fmac_f32 v242, v139, v75
    v_fmac_f32 v242, v140, v76
    v_fmac_f32 v242, v141, v77
    v_fmac_f32 v242, v142, v78
    v_fmac_f32 v242, v143, v79
    v_smfmac_f32_32x32x32_bf16 v[128:143], v[204:207], v[152:159], v249 abid:1
    buffer_load_dword v150, v214, s[4:7], 0 offen
    buffer_load_dword v151, v215, s[4:7], 0 offen
    v_add_f32 v246, v246, v242
    v_cvt_pk_bf16_f32 v241, v241, v242
    ds_write_b32 v248, v241 offset:1024
    v_mul_f32 v239, v232, v235
    v_mul_f32 v240, v233, v235
    v_cvt_pk_bf16_f32 v220, v237, v238
    v_add_u32 v248, s29, v10
    ds_read_b128 v[212:215], v3 offset:480
    s_branch K2_j1
K2_f2:
    ds_read_b64_tr_b16 v[200:201], v4 offset:6144
    ds_read_b64_tr_b16 v[202:203], v4 offset:6656
    ds_read_b64_tr_b16 v[204:205], v5 offset:6144
    ds_read_b64_tr_b16 v[206:207], v5 offset:6656
    s_waitcnt lgkmcnt(5)
    s_ff1_i32_b64 s33, s[30:31]
    s_bitset0_b64 s[30:31], s33
    v_readlane_b32 s28, v12, s33
    s_and_b32 s33, s33, 31
    s_mul_i32 s29, s33, 2064
    v_fma_f32 v241, v80, v16, -v243
    v_fmac_f32 v241, v81, v17
    v_fmac_f32 v241, v82, v18
    v_fmac_f32 v241, v83, v19
    v_fmac_f32 v241, v84, v20
    v_fmac_f32 v241, v85, v21
    v_fmac_f32 v241, v86, v22
    v_fmac_f32 v241, v87, v23
    v_fmac_f32 v241, v88, v24
    v_fmac_f32 v241, v89, v25
    v_fmac_f32 v241, v90, v26
    v_fmac_f32 v241, v91, v27
    v_fmac_f32 v241, v92, v28
    v_fmac_f32 v241, v93, v29
    v_fmac_f32 v241, v94, v30
    v_fmac_f32 v241, v95, v31
    s_sub_u32 s28, s28, 1
    s_waitcnt vmcnt(33)
    v_smfmac_f32_32x32x32_bf16 v[80:95], v[192:195], v[160:167], v249
    buffer_load_dword v152, v208, s[4:7], 0 offen
    buffer_load_dword v153, v209, s[4:7], 0 offen
    v_add_f32 v243, v243, v241
    v_cvt_pk_bf16_f32 v221, v239, v240
    v_mul_f32 v237, v230, v236
    v_fma_f32 v242, v96, v32, -v244
    v_fmac_f32 v242, v97, v33
    v_fmac_f32 v242, v98, v34
    v_fmac_f32 v242, v99, v35
    v_fmac_f32 v242, v100, v36
    v_fmac_f32 v242, v101, v37
    v_fmac_f32 v242, v102, v38
    v_fmac_f32 v242, v103, v39
    v_fmac_f32 v242, v104, v40
    v_fmac_f32 v242, v105, v41
    v_fmac_f32 v242, v106, v42
    v_fmac_f32 v242, v107, v43
    v_fmac_f32 v242, v108, v44
    v_fmac_f32 v242, v109, v45
    v_fmac_f32 v242, v110, v46
    v_fmac_f32 v242, v111, v47
    v_smfmac_f32_32x32x32_bf16 v[96:111], v[192:195], v[160:167], v249 abid:1
    buffer_load_dword v154, v210, s[4:7], 0 offen
    buffer_load_dword v155, v211, s[4:7], 0 offen
    v_add_f32 v244, v244, v242
    v_cvt_pk_bf16_f32 v241, v241, v242
    ds_write_b32 v248, v241 offset:0
    v_mul_f32 v238, v231, v236
    v_mul_f32 v239, v232, v236
    v_mul_f32 v240, v233, v236
    ds_read_b128 v[208:211], v3 offset:512
    v_fma_f32 v241, v112, v48, -v245
    v_fmac_f32 v241, v113, v49
    v_fmac_f32 v241, v114, v50
    v_fmac_f32 v241, v115, v51
    v_fmac_f32 v241, v116, v52
    v_fmac_f32 v241, v117, v53
    v_fmac_f32 v241, v118, v54
    v_fmac_f32 v241, v119, v55
    v_fmac_f32 v241, v120, v56
    v_fmac_f32 v241, v121, v57
    v_fmac_f32 v241, v122, v58
    v_fmac_f32 v241, v123, v59
    v_fmac_f32 v241, v124, v60
    v_fmac_f32 v241, v125, v61
    v_fmac_f32 v241, v126, v62
    v_fmac_f32 v241, v127, v63
    s_waitcnt lgkmcnt(6)
    v_smfmac_f32_32x32x32_bf16 v[112:127], v[196:199], v[160:167], v249
    buffer_load_dword v156, v212, s[4:7], 0 offen
    buffer_load_dword v157, v213, s[4:7], 0 offen
    v_add_f32 v245, v245, v241
    v_cvt_pk_bf16_f32 v222, v237, v238
    v_cvt_pk_bf16_f32 v223, v239, v240
    v_fma_f32 v242, v128, v64, -v246
    v_fmac_f32 v242, v129, v65
    v_fmac_f32 v242, v130, v66
    v_fmac_f32 v242, v131, v67
    v_fmac_f32 v242, v132, v68
    v_fmac_f32 v242, v133, v69
    v_fmac_f32 v242, v134, v70
    v_fmac_f32 v242, v135, v71
    v_fmac_f32 v242, v136, v72
    v_fmac_f32 v242, v137, v73
    v_fmac_f32 v242, v138, v74
    v_fmac_f32 v242, v139, v75
    v_fmac_f32 v242, v140, v76
    v_fmac_f32 v242, v141, v77
    v_fmac_f32 v242, v142, v78
    v_fmac_f32 v242, v143, v79
    v_smfmac_f32_32x32x32_bf16 v[128:143], v[196:199], v[160:167], v249 abid:1
    buffer_load_dword v158, v214, s[4:7], 0 offen
    buffer_load_dword v159, v215, s[4:7], 0 offen
    v_add_f32 v246, v246, v242
    v_cvt_pk_bf16_f32 v241, v241, v242
    ds_write_b32 v248, v241 offset:1024
    ds_write_b128 v7, v[220:223]
    v_xor_b32 v7, 8192, v7
    v_add_u32 v248, s29, v10
    ds_read_b128 v[212:215], v3 offset:544
    s_branch K2_j2
K2_f3:
    s_waitcnt lgkmcnt(1)
    s_ff1_i32_b64 s33, s[30:31]
    s_bitset0_b64 s[30:31], s33
    v_readlane_b32 s28, v12, s33
    s_and_b32 s33, s33, 31
    s_mul_i32 s29, s33, 2064
    v_fma_f32 v241, v80, v16, -v243
    v_fmac_f32 v241, v81, v17
    v_fmac_f32 v241, v82, v18
    v_fmac_f32 v241, v83, v19
    v_fmac_f32 v241, v84, v20
    v_fmac_f32 v241, v85, v21
    v_fmac_f32 v241, v86, v22
    v_fmac_f32 v241, v87, v23
    v_fmac_f32 v241, v88, v24
    v_fmac_f32 v241, v89, v25
    v_fmac_f32 v241, v90, v26
    v_fmac_f32 v241, v91, v27
    v_fmac_f32 v241, v92, v28
    v_fmac_f32 v241, v93, v29
    v_fmac_f32 v241, v94, v30
    v_fmac_f32 v241, v95, v31
    s_sub_u32 s28, s28, 1
    s_waitcnt vmcnt(33)
    v_smfmac_f32_32x32x32_bf16 v[80:95], v[200:203], v[168:175], v249
    buffer_load_dword v160, v208, s[4:7], 0 offen
    buffer_load_dword v161, v209, s[4:7], 0 offen
    v_add_f32 v243, v243, v241
    v_fma_f32 v242, v96, v32, -v244
    v_fmac_f32 v242, v97, v33
    v_fmac_f32 v242, v98, v34
    v_fmac_f32 v242, v99, v35
    v_fmac_f32 v242, v100, v36
    v_fmac_f32 v242, v101, v37
    v_fmac_f32 v242, v102, v38
    v_fmac_f32 v242, v103, v39
    v_fmac_f32 v242, v104, v40
    v_fmac_f32 v242, v105, v41
    v_fmac_f32 v242, v106, v42
    v_fmac_f32 v242, v107, v43
    v_fmac_f32 v242, v108, v44
    v_fmac_f32 v242, v109, v45
    v_fmac_f32 v242, v110, v46
    v_fmac_f32 v242, v111, v47
    v_smfmac_f32_32x32x32_bf16 v[96:111], v[200:203], v[168:175], v249 abid:1
    buffer_load_dword v162, v210, s[4:7], 0 offen
    buffer_load_dword v163, v211, s[4:7], 0 offen
    v_add_f32 v244, v244, v242
    v_cvt_pk_bf16_f32 v241, v241, v242
    ds_write_b32 v248, v241 offset:0
    s_waitcnt lgkmcnt(0)
    s_barrier
    v_xor_b32 v4, 8192, v4
    v_xor_b32 v5, 8192, v5
    ds_read_b64_tr_b16 v[192:193], v4 offset:0
    ds_read_b64_tr_b16 v[194:195], v4 offset:512
    ds_read_b64_tr_b16 v[196:197], v5 offset:0
    ds_read_b64_tr_b16 v[198:199], v5 offset:512
    ds_read_b128 v[208:211], v3 offset:576
    v_fma_f32 v241, v112, v48, -v245
    v_fmac_f32 v241, v113, v49
    v_fmac_f32 v241, v114, v50
    v_fmac_f32 v241, v115, v51
    v_fmac_f32 v241, v116, v52
    v_fmac_f32 v241, v117, v53
    v_fmac_f32 v241, v118, v54
    v_fmac_f32 v241, v119, v55
    v_fmac_f32 v241, v120, v56
    v_fmac_f32 v241, v121, v57
    v_fmac_f32 v241, v122, v58
    v_fmac_f32 v241, v123, v59
    v_fmac_f32 v241, v124, v60
    v_fmac_f32 v241, v125, v61
    v_fmac_f32 v241, v126, v62
    v_fmac_f32 v241, v127, v63
    s_waitcnt lgkmcnt(6)
    v_smfmac_f32_32x32x32_bf16 v[112:127], v[204:207], v[168:175], v249
    buffer_load_dword v164, v212, s[4:7], 0 offen
    buffer_load_dword v165, v213, s[4:7], 0 offen
    v_add_f32 v245, v245, v241
    ds_read_b64 v[226:227], v8 offset:26880
    ds_read_u16 v228, v8 offset:27398
    ds_read_u8 v229, v9 offset:24256
    v_fma_f32 v242, v128, v64, -v246
    v_fmac_f32 v242, v129, v65
    v_fmac_f32 v242, v130, v66
    v_fmac_f32 v242, v131, v67
    v_fmac_f32 v242, v132, v68
    v_fmac_f32 v242, v133, v69
    v_fmac_f32 v242, v134, v70
    v_fmac_f32 v242, v135, v71
    v_fmac_f32 v242, v136, v72
    v_fmac_f32 v242, v137, v73
    v_fmac_f32 v242, v138, v74
    v_fmac_f32 v242, v139, v75
    v_fmac_f32 v242, v140, v76
    v_fmac_f32 v242, v141, v77
    v_fmac_f32 v242, v142, v78
    v_fmac_f32 v242, v143, v79
    v_smfmac_f32_32x32x32_bf16 v[128:143], v[204:207], v[168:175], v249 abid:1
    buffer_load_dword v166, v214, s[4:7], 0 offen
    buffer_load_dword v167, v215, s[4:7], 0 offen
    v_add_f32 v246, v246, v242
    v_cvt_pk_bf16_f32 v241, v241, v242
    ds_write_b32 v248, v241 offset:1024
    v_add_u32 v248, s29, v10
    ds_read_b128 v[212:215], v3 offset:608
    s_branch K2_j3
K2_f4:
    ds_read_b64_tr_b16 v[200:201], v4 offset:2048
    ds_read_b64_tr_b16 v[202:203], v4 offset:2560
    ds_read_b64_tr_b16 v[204:205], v5 offset:2048
    ds_read_b64_tr_b16 v[206:207], v5 offset:2560
    s_waitcnt lgkmcnt(5)
    s_ff1_i32_b64 s33, s[30:31]
    s_bitset0_b64 s[30:31], s33
    v_readlane_b32 s28, v12, s33
    s_and_b32 s33, s33, 31
    s_mul_i32 s29, s33, 2064
    v_fma_f32 v241, v80, v16, -v243
    v_fmac_f32 v241, v81, v17
    v_fmac_f32 v241, v82, v18
    v_fmac_f32 v241, v83, v19
    v_fmac_f32 v241, v84, v20
    v_fmac_f32 v241, v85, v21
    v_fmac_f32 v241, v86, v22
    v_fmac_f32 v241, v87, v23
    v_fmac_f32 v241, v88, v24
    v_fmac_f32 v241, v89, v25
    v_fmac_f32 v241, v90, v26
    v_fmac_f32 v241, v91, v27
    v_fmac_f32 v241, v92, v28
    v_fmac_f32 v241, v93, v29
    v_fmac_f32 v241, v94, v30
    v_fmac_f32 v241, v95, v31
    s_sub_u32 s28, s28, 1
    s_waitcnt vmcnt(28)
    v_smfmac_f32_32x32x32_bf16 v[80:95], v[192:195], v[176:183], v249
    buffer_load_dword v168, v208, s[4:7], 0 offen
    buffer_load_dword v169, v209, s[4:7], 0 offen
    v_add_f32 v243, v243, v241
    v_lshlrev_b32 v230, 16, v224
    v_and_b32 v231, 0xffff0000, v224
    v_lshlrev_b32 v232, 16, v225
    v_and_b32 v233, 0xffff0000, v225
    v_fma_f32 v242, v96, v32, -v244
    v_fmac_f32 v242, v97, v33
    v_fmac_f32 v242, v98, v34
    v_fmac_f32 v242, v99, v35
    v_fmac_f32 v242, v100, v36
    v_fmac_f32 v242, v101, v37
    v_fmac_f32 v242, v102, v38
    v_fmac_f32 v242, v103, v39
    v_fmac_f32 v242, v104, v40
    v_fmac_f32 v242, v105, v41
    v_fmac_f32 v242, v106, v42
    v_fmac_f32 v242, v107, v43
    v_fmac_f32 v242, v108, v44
    v_fmac_f32 v242, v109, v45
    v_fmac_f32 v242, v110, v46
    v_fmac_f32 v242, v111, v47
    v_smfmac_f32_32x32x32_bf16 v[96:111], v[192:195], v[176:183], v249 abid:1
    buffer_load_dword v170, v210, s[4:7], 0 offen
    buffer_load_dword v171, v211, s[4:7], 0 offen
    v_add_f32 v244, v244, v242
    v_cvt_pk_bf16_f32 v241, v241, v242
    ds_write_b32 v248, v241 offset:0
    v_mov_b32 v216, v224
    v_mov_b32 v217, v225
    v_lshl_or_b32 v229, v229, 16, v228
    v_mad_i32_i24 v229, v229, s38, v11
    buffer_load_dwordx2 v[224:225], v229, s[8:11], 0 offen
    ds_read_b128 v[208:211], v3 offset:640
    v_fma_f32 v241, v112, v48, -v245
    v_fmac_f32 v241, v113, v49
    v_fmac_f32 v241, v114, v50
    v_fmac_f32 v241, v115, v51
    v_fmac_f32 v241, v116, v52
    v_fmac_f32 v241, v117, v53
    v_fmac_f32 v241, v118, v54
    v_fmac_f32 v241, v119, v55
    v_fmac_f32 v241, v120, v56
    v_fmac_f32 v241, v121, v57
    v_fmac_f32 v241, v122, v58
    v_fmac_f32 v241, v123, v59
    v_fmac_f32 v241, v124, v60
    v_fmac_f32 v241, v125, v61
    v_fmac_f32 v241, v126, v62
    v_fmac_f32 v241, v127, v63
    s_waitcnt lgkmcnt(6)
    v_smfmac_f32_32x32x32_bf16 v[112:127], v[196:199], v[176:183], v249
    buffer_load_dword v172, v212, s[4:7], 0 offen
    buffer_load_dword v173, v213, s[4:7], 0 offen
    v_add_f32 v245, v245, v241
    v_lshlrev_b32 v234, 16, v226
    v_and_b32 v235, 0xffff0000, v226
    v_lshlrev_b32 v236, 16, v227
    v_fma_f32 v242, v128, v64, -v246
    v_fmac_f32 v242, v129, v65
    v_fmac_f32 v242, v130, v66
    v_fmac_f32 v242, v131, v67
    v_fmac_f32 v242, v132, v68
    v_fmac_f32 v242, v133, v69
    v_fmac_f32 v242, v134, v70
    v_fmac_f32 v242, v135, v71
    v_fmac_f32 v242, v136, v72
    v_fmac_f32 v242, v137, v73
    v_fmac_f32 v242, v138, v74
    v_fmac_f32 v242, v139, v75
    v_fmac_f32 v242, v140, v76
    v_fmac_f32 v242, v141, v77
    v_fmac_f32 v242, v142, v78
    v_fmac_f32 v242, v143, v79
    v_smfmac_f32_32x32x32_bf16 v[128:143], v[196:199], v[176:183], v249 abid:1
    buffer_load_dword v174, v214, s[4:7], 0 offen
    buffer_load_dword v175, v215, s[4:7], 0 offen
    v_add_f32 v246, v246, v242
    v_cvt_pk_bf16_f32 v241, v241, v242
    ds_write_b32 v248, v241 offset:1024
    v_mul_f32 v237, v230, v234
    v_mul_f32 v238, v231, v234
    v_mul_f32 v239, v232, v234
    v_add_u32 v248, s29, v10
    ds_read_b128 v[212:215], v3 offset:672
    s_branch K2_j4
K2_f5:
    ds_read_b64_tr_b16 v[192:193], v4 offset:4096
    ds_read_b64_tr_b16 v[194:195], v4 offset:4608
    ds_read_b64_tr_b16 v[196:197], v5 offset:4096
    ds_read_b64_tr_b16 v[198:199], v5 offset:4608
    s_waitcnt lgkmcnt(5)
    s_ff1_i32_b64 s33, s[30:31]
    s_bitset0_b64 s[30:31], s33
    v_readlane_b32 s28, v12, s33
    s_and_b32 s33, s33, 31
    s_mul_i32 s29, s33, 2064
    v_fma_f32 v241, v80, v16, -v243
    v_fmac_f32 v241, v81, v17
    v_fmac_f32 v241, v82, v18
    v_fmac_f32 v241, v83, v19
    v_fmac_f32 v241, v84, v20
    v_fmac_f32 v241, v85, v21
    v_fmac_f32 v241, v86, v22
    v_fmac_f32 v241, v87, v23
    v_fmac_f32 v241, v88, v24
    v_fmac_f32 v241, v89, v25
    v_fmac_f32 v241, v90, v26
    v_fmac_f32 v241, v91, v27
    v_fmac_f32 v241, v92, v28
    v_fmac_f32 v241, v93, v29
    v_fmac_f32 v241, v94, v30
    v_fmac_f32 v241, v95, v31
    s_sub_u32 s28, s28, 1
    s_waitcnt vmcnt(33)
    v_smfmac_f32_32x32x32_bf16 v[80:95], v[200:203], v[184:191], v249
    buffer_load_dword v176, v208, s[4:7], 0 offen
    buffer_load_dword v177, v209, s[4:7], 0 offen
    v_add_f32 v243, v243, v241
    v_mul_f32 v240, v233, v234
    v_cvt_pk_bf16_f32 v218, v237, v238
    v_fma_f32 v242, v96, v32, -v244
    v_fmac_f32 v242, v97, v33
    v_fmac_f32 v242, v98, v34
    v_fmac_f32 v242, v99, v35
    v_fmac_f32 v242, v100, v36
    v_fmac_f32 v242, v101, v37
    v_fmac_f32 v242, v102, v38
    v_fmac_f32 v242, v103, v39
    v_fmac_f32 v242, v104, v40
    v_fmac_f32 v242, v105, v41
    v_fmac_f32 v242, v106, v42
    v_fmac_f32 v242, v107, v43
    v_fmac_f32 v242, v108, v44
    v_fmac_f32 v242, v109, v45
    v_fmac_f32 v242, v110, v46
    v_fmac_f32 v242, v111, v47
    v_smfmac_f32_32x32x32_bf16 v[96:111], v[200:203], v[184:191], v249 abid:1
    buffer_load_dword v178, v210, s[4:7], 0 offen
    buffer_load_dword v179, v211, s[4:7], 0 offen
    v_add_f32 v244, v244, v242
    v_cvt_pk_bf16_f32 v241, v241, v242
    ds_write_b32 v248, v241 offset:0
    v_cvt_pk_bf16_f32 v219, v239, v240
    ds_write_b128 v6, v[216:219]
    v_xor_b32 v6, 8192, v6
    ds_read_b128 v[208:211], v3 offset:704
    v_fma_f32 v241, v112, v48, -v245
    v_fmac_f32 v241, v113, v49
    v_fmac_f32 v241, v114, v50
    v_fmac_f32 v241, v115, v51
    v_fmac_f32 v241, v116, v52
    v_fmac_f32 v241, v117, v53
    v_fmac_f32 v241, v118, v54
    v_fmac_f32 v241, v119, v55
    v_fmac_f32 v241, v120, v56
    v_fmac_f32 v241, v121, v57
    v_fmac_f32 v241, v122, v58
    v_fmac_f32 v241, v123, v59
    v_fmac_f32 v241, v124, v60
    v_fmac_f32 v241, v125, v61
    v_fmac_f32 v241, v126, v62
    v_fmac_f32 v241, v127, v63
    s_waitcnt lgkmcnt(7)
    v_smfmac_f32_32x32x32_bf16 v[112:127], v[204:207], v[184:191], v249
    buffer_load_dword v180, v212, s[4:7], 0 offen
    buffer_load_dword v181, v213, s[4:7], 0 offen
    v_add_f32 v245, v245, v241
    v_mul_f32 v237, v230, v235
    v_mul_f32 v238, v231, v235
    v_fma_f32 v242, v128, v64, -v246
    v_fmac_f32 v242, v129, v65
    v_fmac_f32 v242, v130, v66
    v_fmac_f32 v242, v131, v67
    v_fmac_f32 v242, v132, v68
    v_fmac_f32 v242, v133, v69
    v_fmac_f32 v242, v134, v70
    v_fmac_f32 v242, v135, v71
    v_fmac_f32 v242, v136, v72
    v_fmac_f32 v242, v137, v73
    v_fmac_f32 v242, v138, v74
    v_fmac_f32 v242, v139, v75
    v_fmac_f32 v242, v140, v76
    v_fmac_f32 v242, v141, v77
    v_fmac_f32 v242, v142, v78
    v_fmac_f32 v242, v143, v79
    v_smfmac_f32_32x32x32_bf16 v[128:143], v[204:207], v[184:191], v249 abid:1
    buffer_load_dword v182, v214, s[4:7], 0 offen
    buffer_load_dword v183, v215, s[4:7], 0 offen
    v_add_f32 v246, v246, v242
    v_cvt_pk_bf16_f32 v241, v241, v242
    ds_write_b32 v248, v241 offset:1024
    v_mul_f32 v239, v232, v235
    v_mul_f32 v240, v233, v235
    v_cvt_pk_bf16_f32 v220, v237, v238
    v_add_u32 v248, s29, v10
    ds_read_b128 v[212:215], v3 offset:736
    s_branch K2_j5
K2_f6:
    ds_read_b64_tr_b16 v[200:201], v4 offset:6144
    ds_read_b64_tr_b16 v[202:203], v4 offset:6656
    ds_read_b64_tr_b16 v[204:205], v5 offset:6144
    ds_read_b64_tr_b16 v[206:207], v5 offset:6656
    s_waitcnt lgkmcnt(5)
    s_ff1_i32_b64 s33, s[30:31]
    s_bitset0_b64 s[30:31], s33
    v_readlane_b32 s28, v12, s33
    s_and_b32 s33, s33, 31
    s_mul_i32 s29, s33, 2064
    v_fma_f32 v241, v80, v16, -v243
    v_fmac_f32 v241, v81, v17
    v_fmac_f32 v241, v82, v18
    v_fmac_f32 v241, v83, v19
    v_fmac_f32 v241, v84, v20
    v_fmac_f32 v241, v85, v21
    v_fmac_f32 v241, v86, v22
    v_fmac_f32 v241, v87, v23
    v_fmac_f32 v241, v88, v24
    v_fmac_f32 v241, v89, v25
    v_fmac_f32 v241, v90, v26
    v_fmac_f32 v241, v91, v27
    v_fmac_f32 v241, v92, v28
    v_fmac_f32 v241, v93, v29
    v_fmac_f32 v241, v94, v30
    v_fmac_f32 v241, v95, v31
    s_sub_u32 s28, s28, 1
    s_waitcnt vmcnt(33)
    v_smfmac_f32_32x32x32_bf16 v[80:95], v[192:195], v[144:151], v249
    buffer_load_dword v184, v208, s[4:7], 0 offen
    buffer_load_dword v185, v209, s[4:7], 0 offen
    v_add_f32 v243, v243, v241
    v_cvt_pk_bf16_f32 v221, v239, v240
    v_mul_f32 v237, v230, v236
    v_fma_f32 v242, v96, v32, -v244
    v_fmac_f32 v242, v97, v33
    v_fmac_f32 v242, v98, v34
    v_fmac_f32 v242, v99, v35
    v_fmac_f32 v242, v100, v36
    v_fmac_f32 v242, v101, v37
    v_fmac_f32 v242, v102, v38
    v_fmac_f32 v242, v103, v39
    v_fmac_f32 v242, v104, v40
    v_fmac_f32 v242, v105, v41
    v_fmac_f32 v242, v106, v42
    v_fmac_f32 v242, v107, v43
    v_fmac_f32 v242, v108, v44
    v_fmac_f32 v242, v109, v45
    v_fmac_f32 v242, v110, v46
    v_fmac_f32 v242, v111, v47
    v_smfmac_f32_32x32x32_bf16 v[96:111], v[192:195], v[144:151], v249 abid:1
    buffer_load_dword v186, v210, s[4:7], 0 offen
    buffer_load_dword v187, v211, s[4:7], 0 offen
    v_add_f32 v244, v244, v242
    v_cvt_pk_bf16_f32 v241, v241, v242
    ds_write_b32 v248, v241 offset:0
    v_mul_f32 v238, v231, v236
    v_mul_f32 v239, v232, v236
    v_mul_f32 v240, v233, v236
    ds_read_b128 v[208:211], v3 offset:768
    v_fma_f32 v241, v112, v48, -v245
    v_fmac_f32 v241, v113, v49
    v_fmac_f32 v241, v114, v50
    v_fmac_f32 v241, v115, v51
    v_fmac_f32 v241, v116, v52
    v_fmac_f32 v241, v117, v53
    v_fmac_f32 v241, v118, v54
    v_fmac_f32 v241, v119, v55
    v_fmac_f32 v241, v120, v56
    v_fmac_f32 v241, v121, v57
    v_fmac_f32 v241, v122, v58
    v_fmac_f32 v241, v123, v59
    v_fmac_f32 v241, v124, v60
    v_fmac_f32 v241, v125, v61
    v_fmac_f32 v241, v126, v62
    v_fmac_f32 v241, v127, v63
    s_waitcnt lgkmcnt(6)
    v_smfmac_f32_32x32x32_bf16 v[112:127], v[196:199], v[144:151], v249
    buffer_load_dword v188, v212, s[4:7], 0 offen
    buffer_load_dword v189, v213, s[4:7], 0 offen
    v_add_f32 v245, v245, v241
    v_cvt_pk_bf16_f32 v222, v237, v238
    v_cvt_pk_bf16_f32 v223, v239, v240
    v_fma_f32 v242, v128, v64, -v246
    v_fmac_f32 v242, v129, v65
    v_fmac_f32 v242, v130, v66
    v_fmac_f32 v242, v131, v67
    v_fmac_f32 v242, v132, v68
    v_fmac_f32 v242, v133, v69
    v_fmac_f32 v242, v134, v70
    v_fmac_f32 v242, v135, v71
    v_fmac_f32 v242, v136, v72
    v_fmac_f32 v242, v137, v73
    v_fmac_f32 v242, v138, v74
    v_fmac_f32 v242, v139, v75
    v_fmac_f32 v242, v140, v76
    v_fmac_f32 v242, v141, v77
    v_fmac_f32 v242, v142, v78
    v_fmac_f32 v242, v143, v79
    v_smfmac_f32_32x32x32_bf16 v[128:143], v[196:199], v[144:151], v249 abid:1
    buffer_load_dword v190, v214, s[4:7], 0 offen
    buffer_load_dword v191, v215, s[4:7], 0 offen
    v_add_f32 v246, v246, v242
    v_cvt_pk_bf16_f32 v241, v241, v242
    ds_write_b32 v248, v241 offset:1024
    ds_write_b128 v7, v[220:223]
    v_xor_b32 v7, 8192, v7
    v_add_u32 v248, s29, v10
    ds_read_b128 v[212:215], v3 offset:800
    s_branch K2_j6
K2_f7:
    s_waitcnt lgkmcnt(1)
    s_ff1_i32_b64 s33, s[30:31]
    s_bitset0_b64 s[30:31], s33
    v_readlane_b32 s28, v12, s33
    s_and_b32 s33, s33, 31
    s_mul_i32 s29, s33, 2064
    v_fma_f32 v241, v80, v16, -v243
    v_fmac_f32 v241, v81, v17
    v_fmac_f32 v241, v82, v18
    v_fmac_f32 v241, v83, v19
    v_fmac_f32 v241, v84, v20
    v_fmac_f32 v241, v85, v21
    v_fmac_f32 v241, v86, v22
    v_fmac_f32 v241, v87, v23
    v_fmac_f32 v241, v88, v24
    v_fmac_f32 v241, v89, v25
    v_fmac_f32 v241, v90, v26
    v_fmac_f32 v241, v91, v27
    v_fmac_f32 v241, v92, v28
    v_fmac_f32 v241, v93, v29
    v_fmac_f32 v241, v94, v30
    v_fmac_f32 v241, v95, v31
    s_sub_u32 s28, s28, 1
    s_waitcnt vmcnt(33)
    v_smfmac_f32_32x32x32_bf16 v[80:95], v[200:203], v[152:159], v249
    buffer_load_dword v144, v208, s[4:7], 0 offen
    buffer_load_dword v145, v209, s[4:7], 0 offen
    v_add_f32 v243, v243, v241
    v_fma_f32 v242, v96, v32, -v244
    v_fmac_f32 v242, v97, v33
    v_fmac_f32 v242, v98, v34
    v_fmac_f32 v242, v99, v35
    v_fmac_f32 v242, v100, v36
    v_fmac_f32 v242, v101, v37
    v_fmac_f32 v242, v102, v38
    v_fmac_f32 v242, v103, v39
    v_fmac_f32 v242, v104, v40
    v_fmac_f32 v242, v105, v41
    v_fmac_f32 v242, v106, v42
    v_fmac_f32 v242, v107, v43
    v_fmac_f32 v242, v108, v44
    v_fmac_f32 v242, v109, v45
    v_fmac_f32 v242, v110, v46
    v_fmac_f32 v242, v111, v47
    v_smfmac_f32_32x32x32_bf16 v[96:111], v[200:203], v[152:159], v249 abid:1
    buffer_load_dword v146, v210, s[4:7], 0 offen
    buffer_load_dword v147, v211, s[4:7], 0 offen
    v_add_f32 v244, v244, v242
    v_cvt_pk_bf16_f32 v241, v241, v242
    ds_write_b32 v248, v241 offset:0
    s_waitcnt lgkmcnt(0)
    s_barrier
    v_xor_b32 v4, 8192, v4
    v_xor_b32 v5, 8192, v5
    ds_read_b64_tr_b16 v[192:193], v4 offset:0
    ds_read_b64_tr_b16 v[194:195], v4 offset:512
    ds_read_b64_tr_b16 v[196:197], v5 offset:0
    ds_read_b64_tr_b16 v[198:199], v5 offset:512
    ds_read_b128 v[208:211], v3 offset:832
    v_fma_f32 v241, v112, v48, -v245
    v_fmac_f32 v241, v113, v49
    v_fmac_f32 v241, v114, v50
    v_fmac_f32 v241, v115, v51
    v_fmac_f32 v241, v116, v52
    v_fmac_f32 v241, v117, v53
    v_fmac_f32 v241, v118, v54
    v_fmac_f32 v241, v119, v55
    v_fmac_f32 v241, v120, v56
    v_fmac_f32 v241, v121, v57
    v_fmac_f32 v241, v122, v58
    v_fmac_f32 v241, v123, v59
    v_fmac_f32 v241, v124, v60
    v_fmac_f32 v241, v125, v61
    v_fmac_f32 v241, v126, v62
    v_fmac_f32 v241, v127, v63
    s_waitcnt lgkmcnt(6)
    v_smfmac_f32_32x32x32_bf16 v[112:127], v[204:207], v[152:159], v249
    buffer_load_dword v148, v212, s[4:7], 0 offen
    buffer_load_dword v149, v213, s[4:7], 0 offen
    v_add_f32 v245, v245, v241
    ds_read_b64 v[226:227], v8 offset:27392
    ds_read_u16 v228, v8 offset:27910
    ds_read_u8 v229, v9 offset:24320
    v_fma_f32 v242, v128, v64, -v246
    v_fmac_f32 v242, v129, v65
    v_fmac_f32 v242, v130, v66
    v_fmac_f32 v242, v131, v67
    v_fmac_f32 v242, v132, v68
    v_fmac_f32 v242, v133, v69
    v_fmac_f32 v242, v134, v70
    v_fmac_f32 v242, v135, v71
    v_fmac_f32 v242, v136, v72
    v_fmac_f32 v242, v137, v73
    v_fmac_f32 v242, v138, v74
    v_fmac_f32 v242, v139, v75
    v_fmac_f32 v242, v140, v76
    v_fmac_f32 v242, v141, v77
    v_fmac_f32 v242, v142, v78
    v_fmac_f32 v242, v143, v79
    v_smfmac_f32_32x32x32_bf16 v[128:143], v[204:207], v[152:159], v249 abid:1
    buffer_load_dword v150, v214, s[4:7], 0 offen
    buffer_load_dword v151, v215, s[4:7], 0 offen
    v_add_f32 v246, v246, v242
    v_cvt_pk_bf16_f32 v241, v241, v242
    ds_write_b32 v248, v241 offset:1024
    v_add_u32 v248, s29, v10
    ds_read_b128 v[212:215], v3 offset:864
    s_branch K2_j7
K2_f8:
    ds_read_b64_tr_b16 v[200:201], v4 offset:2048
    ds_read_b64_tr_b16 v[202:203], v4 offset:2560
    ds_read_b64_tr_b16 v[204:205], v5 offset:2048
    ds_read_b64_tr_b16 v[206:207], v5 offset:2560
    s_waitcnt lgkmcnt(5)
    s_ff1_i32_b64 s33, s[30:31]
    s_bitset0_b64 s[30:31], s33
    v_readlane_b32 s28, v12, s33
    s_and_b32 s33, s33, 31
    s_mul_i32 s29, s33, 2064
    v_fma_f32 v241, v80, v16, -v243
    v_fmac_f32 v241, v81, v17
    v_fmac_f32 v241, v82, v18
    v_fmac_f32 v241, v83, v19
    v_fmac_f32 v241, v84, v20
    v_fmac_f32 v241, v85, v21
    v_fmac_f32 v241, v86, v22
    v_fmac_f32 v241, v87, v23
    v_fmac_f32 v241, v88, v24
    v_fmac_f32 v241, v89, v25
    v_fmac_f32 v241, v90, v26
    v_fmac_f32 v241, v91, v27
    v_fmac_f32 v241, v92, v28
    v_fmac_f32 v241, v93, v29
    v_fmac_f32 v241, v94, v30
    v_fmac_f32 v241, v95, v31
    s_sub_u32 s28, s28, 1
    s_waitcnt vmcnt(28)
    v_smfmac_f32_32x32x32_bf16 v[80:95], v[192:195], v[160:167], v249
    buffer_load_dword v152, v208, s[4:7], 0 offen
    buffer_load_dword v153, v209, s[4:7], 0 offen
    v_add_f32 v243, v243, v241
    v_lshlrev_b32 v230, 16, v224
    v_and_b32 v231, 0xffff0000, v224
    v_lshlrev_b32 v232, 16, v225
    v_and_b32 v233, 0xffff0000, v225
    v_fma_f32 v242, v96, v32, -v244
    v_fmac_f32 v242, v97, v33
    v_fmac_f32 v242, v98, v34
    v_fmac_f32 v242, v99, v35
    v_fmac_f32 v242, v100, v36
    v_fmac_f32 v242, v101, v37
    v_fmac_f32 v242, v102, v38
    v_fmac_f32 v242, v103, v39
    v_fmac_f32 v242, v104, v40
    v_fmac_f32 v242, v105, v41
    v_fmac_f32 v242, v106, v42
    v_fmac_f32 v242, v107, v43
    v_fmac_f32 v242, v108, v44
    v_fmac_f32 v242, v109, v45
    v_fmac_f32 v242, v110, v46
    v_fmac_f32 v242, v111, v47
    v_smfmac_f32_32x32x32_bf16 v[96:111], v[192:195], v[160:167], v249 abid:1
    buffer_load_dword v154, v210, s[4:7], 0 offen
    buffer_load_dword v155, v211, s[4:7], 0 offen
    v_add_f32 v244, v244, v242
    v_cvt_pk_bf16_f32 v241, v241, v242
    ds_write_b32 v248, v241 offset:0
    v_mov_b32 v216, v224
    v_mov_b32 v217, v225
    v_lshl_or_b32 v229, v229, 16, v228
    v_mad_i32_i24 v229, v229, s38, v11
    buffer_load_dwordx2 v[224:225], v229, s[8:11], 0 offen
    ds_read_b128 v[208:211], v3 offset:896
    v_fma_f32 v241, v112, v48, -v245
    v_fmac_f32 v241, v113, v49
    v_fmac_f32 v241, v114, v50
    v_fmac_f32 v241, v115, v51
    v_fmac_f32 v241, v116, v52
    v_fmac_f32 v241, v117, v53
    v_fmac_f32 v241, v118, v54
    v_fmac_f32 v241, v119, v55
    v_fmac_f32 v241, v120, v56
    v_fmac_f32 v241, v121, v57
    v_fmac_f32 v241, v122, v58
    v_fmac_f32 v241, v123, v59
    v_fmac_f32 v241, v124, v60
    v_fmac_f32 v241, v125, v61
    v_fmac_f32 v241, v126, v62
    v_fmac_f32 v241, v127, v63
    s_waitcnt lgkmcnt(6)
    v_smfmac_f32_32x32x32_bf16 v[112:127], v[196:199], v[160:167], v249
    buffer_load_dword v156, v212, s[4:7], 0 offen
    buffer_load_dword v157, v213, s[4:7], 0 offen
    v_add_f32 v245, v245, v241
    v_lshlrev_b32 v234, 16, v226
    v_and_b32 v235, 0xffff0000, v226
    v_lshlrev_b32 v236, 16, v227
    v_fma_f32 v242, v128, v64, -v246
    v_fmac_f32 v242, v129, v65
    v_fmac_f32 v242, v130, v66
    v_fmac_f32 v242, v131, v67
    v_fmac_f32 v242, v132, v68
    v_fmac_f32 v242, v133, v69
    v_fmac_f32 v242, v134, v70
    v_fmac_f32 v242, v135, v71
    v_fmac_f32 v242, v136, v72
    v_fmac_f32 v242, v137, v73
    v_fmac_f32 v242, v138, v74
    v_fmac_f32 v242, v139, v75
    v_fmac_f32 v242, v140, v76
    v_fmac_f32 v242, v141, v77
    v_fmac_f32 v242, v142, v78
    v_fmac_f32 v242, v143, v79
    v_smfmac_f32_32x32x32_bf16 v[128:143], v[196:199], v[160:167], v249 abid:1
    buffer_load_dword v158, v214, s[4:7], 0 offen
    buffer_load_dword v159, v215, s[4:7], 0 offen
    v_add_f32 v246, v246, v242
    v_cvt_pk_bf16_f32 v241, v241, v242
    ds_write_b32 v248, v241 offset:1024
    v_mul_f32 v237, v230, v234
    v_mul_f32 v238, v231, v234
    v_mul_f32 v239, v232, v234
    v_add_u32 v248, s29, v10
    ds_read_b128 v[212:215], v3 offset:928
    s_branch K2_j8
K2_f9:
    ds_read_b64_tr_b16 v[192:193], v4 offset:4096
    ds_read_b64_tr_b16 v[194:195], v4 offset:4608
    ds_read_b64_tr_b16 v[196:197], v5 offset:4096
    ds_read_b64_tr_b16 v[198:199], v5 offset:4608
    s_waitcnt lgkmcnt(5)
    s_ff1_i32_b64 s33, s[30:31]
    s_bitset0_b64 s[30:31], s33
    v_readlane_b32 s28, v12, s33
    s_and_b32 s33, s33, 31
    s_mul_i32 s29, s33, 2064
    v_fma_f32 v241, v80, v16, -v243
    v_fmac_f32 v241, v81, v17
    v_fmac_f32 v241, v82, v18
    v_fmac_f32 v241, v83, v19
    v_fmac_f32 v241, v84, v20
    v_fmac_f32 v241, v85, v21
    v_fmac_f32 v241, v86, v22
    v_fmac_f32 v241, v87, v23
    v_fmac_f32 v241, v88, v24
    v_fmac_f32 v241, v89, v25
    v_fmac_f32 v241, v90, v26
    v_fmac_f32 v241, v91, v27
    v_fmac_f32 v241, v92, v28
    v_fmac_f32 v241, v93, v29
    v_fmac_f32 v241, v94, v30
    v_fmac_f32 v241, v95, v31
    s_sub_u32 s28, s28, 1
    s_waitcnt vmcnt(33)
    v_smfmac_f32_32x32x32_bf16 v[80:95], v[200:203], v[168:175], v249
    buffer_load_dword v160, v208, s[4:7], 0 offen
    buffer_load_dword v161, v209, s[4:7], 0 offen
    v_add_f32 v243, v243, v241
    v_mul_f32 v240, v233, v234
    v_cvt_pk_bf16_f32 v218, v237, v238
    v_fma_f32 v242, v96, v32, -v244
    v_fmac_f32 v242, v97, v33
    v_fmac_f32 v242, v98, v34
    v_fmac_f32 v242, v99, v35
    v_fmac_f32 v242, v100, v36
    v_fmac_f32 v242, v101, v37
    v_fmac_f32 v242, v102, v38
    v_fmac_f32 v242, v103, v39
    v_fmac_f32 v242, v104, v40
    v_fmac_f32 v242, v105, v41
    v_fmac_f32 v242, v106, v42
    v_fmac_f32 v242, v107, v43
    v_fmac_f32 v242, v108, v44
    v_fmac_f32 v242, v109, v45
    v_fmac_f32 v242, v110, v46
    v_fmac_f32 v242, v111, v47
    v_smfmac_f32_32x32x32_bf16 v[96:111], v[200:203], v[168:175], v249 abid:1
    buffer_load_dword v162, v210, s[4:7], 0 offen
    buffer_load_dword v163, v211, s[4:7], 0 offen
    v_add_f32 v244, v244, v242
    v_cvt_pk_bf16_f32 v241, v241, v242
    ds_write_b32 v248, v241 offset:0
    v_cvt_pk_bf16_f32 v219, v239, v240
    ds_write_b128 v6, v[216:219]
    v_xor_b32 v6, 8192, v6
    ds_read_b128 v[208:211], v3 offset:960
    v_fma_f32 v241, v112, v48, -v245
    v_fmac_f32 v241, v113, v49
    v_fmac_f32 v241, v114, v50
    v_fmac_f32 v241, v115, v51
    v_fmac_f32 v241, v116, v52
    v_fmac_f32 v241, v117, v53
    v_fmac_f32 v241, v118, v54
    v_fmac_f32 v241, v119, v55
    v_fmac_f32 v241, v120, v56
    v_fmac_f32 v241, v121, v57
    v_fmac_f32 v241, v122, v58
    v_fmac_f32 v241, v123, v59
    v_fmac_f32 v241, v124, v60
    v_fmac_f32 v241, v125, v61
    v_fmac_f32 v241, v126, v62
    v_fmac_f32 v241, v127, v63
    s_waitcnt lgkmcnt(7)
    v_smfmac_f32_32x32x32_bf16 v[112:127], v[204:207], v[168:175], v249
    buffer_load_dword v164, v212, s[4:7], 0 offen
    buffer_load_dword v165, v213, s[4:7], 0 offen
    v_add_f32 v245, v245, v241
    v_mul_f32 v237, v230, v235
    v_mul_f32 v238, v231, v235
    v_fma_f32 v242, v128, v64, -v246
    v_fmac_f32 v242, v129, v65
    v_fmac_f32 v242, v130, v66
    v_fmac_f32 v242, v131, v67
    v_fmac_f32 v242, v132, v68
    v_fmac_f32 v242, v133, v69
    v_fmac_f32 v242, v134, v70
    v_fmac_f32 v242, v135, v71
    v_fmac_f32 v242, v136, v72
    v_fmac_f32 v242, v137, v73
    v_fmac_f32 v242, v138, v74
    v_fmac_f32 v242, v139, v75
    v_fmac_f32 v242, v140, v76
    v_fmac_f32 v242, v141, v77
    v_fmac_f32 v242, v142, v78
    v_fmac_f32 v242, v143, v79
    v_smfmac_f32_32x32x32_bf16 v[128:143], v[204:207], v[168:175], v249 abid:1
    buffer_load_dword v166, v214, s[4:7], 0 offen
    buffer_load_dword v167, v215, s[4:7], 0 offen
    v_add_f32 v246, v246, v242
    v_cvt_pk_bf16_f32 v241, v241, v242
    ds_write_b32 v248, v241 offset:1024
    v_mul_f32 v239, v232, v235
    v_mul_f32 v240, v233, v235
    v_cvt_pk_bf16_f32 v220, v237, v238
    v_add_u32 v248, s29, v10
    ds_read_b128 v[212:215], v3 offset:992
    s_branch K2_j9
K2_f10:
    ds_read_b64_tr_b16 v[200:201], v4 offset:6144
    ds_read_b64_tr_b16 v[202:203], v4 offset:6656
    ds_read_b64_tr_b16 v[204:205], v5 offset:6144
    ds_read_b64_tr_b16 v[206:207], v5 offset:6656
    s_waitcnt lgkmcnt(5)
    s_ff1_i32_b64 s33, s[30:31]
    s_bitset0_b64 s[30:31], s33
    v_readlane_b32 s28, v12, s33
    s_and_b32 s33, s33, 31
    s_mul_i32 s29, s33, 2064
    v_fma_f32 v241, v80, v16, -v243
    v_fmac_f32 v241, v81, v17
    v_fmac_f32 v241, v82, v18
    v_fmac_f32 v241, v83, v19
    v_fmac_f32 v241, v84, v20
    v_fmac_f32 v241, v85, v21
    v_fmac_f32 v241, v86, v22
    v_fmac_f32 v241, v87, v23
    v_fmac_f32 v241, v88, v24
    v_fmac_f32 v241, v89, v25
    v_fmac_f32 v241, v90, v26
    v_fmac_f32 v241, v91, v27
    v_fmac_f32 v241, v92, v28
    v_fmac_f32 v241, v93, v29
    v_fmac_f32 v241, v94, v30
    v_fmac_f32 v241, v95, v31
    s_sub_u32 s28, s28, 1
    s_waitcnt vmcnt(33)
    v_smfmac_f32_32x32x32_bf16 v[80:95], v[192:195], v[176:183], v249
    buffer_load_dword v168, v208, s[4:7], 0 offen
    buffer_load_dword v169, v209, s[4:7], 0 offen
    v_add_f32 v243, v243, v241
    v_cvt_pk_bf16_f32 v221, v239, v240
    v_mul_f32 v237, v230, v236
    v_fma_f32 v242, v96, v32, -v244
    v_fmac_f32 v242, v97, v33
    v_fmac_f32 v242, v98, v34
    v_fmac_f32 v242, v99, v35
    v_fmac_f32 v242, v100, v36
    v_fmac_f32 v242, v101, v37
    v_fmac_f32 v242, v102, v38
    v_fmac_f32 v242, v103, v39
    v_fmac_f32 v242, v104, v40
    v_fmac_f32 v242, v105, v41
    v_fmac_f32 v242, v106, v42
    v_fmac_f32 v242, v107, v43
    v_fmac_f32 v242, v108, v44
    v_fmac_f32 v242, v109, v45
    v_fmac_f32 v242, v110, v46
    v_fmac_f32 v242, v111, v47
    v_smfmac_f32_32x32x32_bf16 v[96:111], v[192:195], v[176:183], v249 abid:1
    buffer_load_dword v170, v210, s[4:7], 0 offen
    buffer_load_dword v171, v211, s[4:7], 0 offen
    v_add_f32 v244, v244, v242
    v_cvt_pk_bf16_f32 v241, v241, v242
    ds_write_b32 v248, v241 offset:0
    v_mul_f32 v238, v231, v236
    v_mul_f32 v239, v232, v236
    v_mul_f32 v240, v233, v236
    ds_read_b128 v[208:211], v3 offset:1024
    v_fma_f32 v241, v112, v48, -v245
    v_fmac_f32 v241, v113, v49
    v_fmac_f32 v241, v114, v50
    v_fmac_f32 v241, v115, v51
    v_fmac_f32 v241, v116, v52
    v_fmac_f32 v241, v117, v53
    v_fmac_f32 v241, v118, v54
    v_fmac_f32 v241, v119, v55
    v_fmac_f32 v241, v120, v56
    v_fmac_f32 v241, v121, v57
    v_fmac_f32 v241, v122, v58
    v_fmac_f32 v241, v123, v59
    v_fmac_f32 v241, v124, v60
    v_fmac_f32 v241, v125, v61
    v_fmac_f32 v241, v126, v62
    v_fmac_f32 v241, v127, v63
    s_waitcnt lgkmcnt(6)
    v_smfmac_f32_32x32x32_bf16 v[112:127], v[196:199], v[176:183], v249
    buffer_load_dword v172, v212, s[4:7], 0 offen
    buffer_load_dword v173, v213, s[4:7], 0 offen
    v_add_f32 v245, v245, v241
    v_cvt_pk_bf16_f32 v222, v237, v238
    v_cvt_pk_bf16_f32 v223, v239, v240
    v_fma_f32 v242, v128, v64, -v246
    v_fmac_f32 v242, v129, v65
    v_fmac_f32 v242, v130, v66
    v_fmac_f32 v242, v131, v67
    v_fmac_f32 v242, v132, v68
    v_fmac_f32 v242, v133, v69
    v_fmac_f32 v242, v134, v70
    v_fmac_f32 v242, v135, v71
    v_fmac_f32 v242, v136, v72
    v_fmac_f32 v242, v137, v73
    v_fmac_f32 v242, v138, v74
    v_fmac_f32 v242, v139, v75
    v_fmac_f32 v242, v140, v76
    v_fmac_f32 v242, v141, v77
    v_fmac_f32 v242, v142, v78
    v_fmac_f32 v242, v143, v79
    v_smfmac_f32_32x32x32_bf16 v[128:143], v[196:199], v[176:183], v249 abid:1
    buffer_load_dword v174, v214, s[4:7], 0 offen
    buffer_load_dword v175, v215, s[4:7], 0 offen
    v_add_f32 v246, v246, v242
    v_cvt_pk_bf16_f32 v241, v241, v242
    ds_write_b32 v248, v241 offset:1024
    ds_write_b128 v7, v[220:223]
    v_xor_b32 v7, 8192, v7
    v_add_u32 v248, s29, v10
    ds_read_b128 v[212:215], v3 offset:1056
    s_branch K2_j10
K2_f11:
    s_waitcnt lgkmcnt(1)
    s_ff1_i32_b64 s33, s[30:31]
    s_bitset0_b64 s[30:31], s33
    v_readlane_b32 s28, v12, s33
    s_and_b32 s33, s33, 31
    s_mul_i32 s29, s33, 2064
    v_fma_f32 v241, v80, v16, -v243
    v_fmac_f32 v241, v81, v17
    v_fmac_f32 v241, v82, v18
    v_fmac_f32 v241, v83, v19
    v_fmac_f32 v241, v84, v20
    v_fmac_f32 v241, v85, v21
    v_fmac_f32 v241, v86, v22
    v_fmac_f32 v241, v87, v23
    v_fmac_f32 v241, v88, v24
    v_fmac_f32 v241, v89, v25
    v_fmac_f32 v241, v90, v26
    v_fmac_f32 v241, v91, v27
    v_fmac_f32 v241, v92, v28
    v_fmac_f32 v241, v93, v29
    v_fmac_f32 v241, v94, v30
    v_fmac_f32 v241, v95, v31
    s_sub_u32 s28, s28, 1
    s_waitcnt vmcnt(33)
    v_smfmac_f32_32x32x32_bf16 v[80:95], v[200:203], v[184:191], v249
    buffer_load_dword v176, v208, s[4:7], 0 offen
    buffer_load_dword v177, v209, s[4:7], 0 offen
    v_add_f32 v243, v243, v241
    v_add_u32 v3, 768, v3
    v_add_u32 v8, 1536, v8
    v_add_u32 v9, 192, v9
    v_fma_f32 v242, v96, v32, -v244
    v_fmac_f32 v242, v97, v33
    v_fmac_f32 v242, v98, v34
    v_fmac_f32 v242, v99, v35
    v_fmac_f32 v242, v100, v36
    v_fmac_f32 v242, v101, v37
    v_fmac_f32 v242, v102, v38
    v_fmac_f32 v242, v103, v39
    v_fmac_f32 v242, v104, v40
    v_fmac_f32 v242, v105, v41
    v_fmac_f32 v242, v106, v42
    v_fmac_f32 v242, v107, v43
    v_fmac_f32 v242, v108, v44
    v_fmac_f32 v242, v109, v45
    v_fmac_f32 v242, v110, v46
    v_fmac_f32 v242, v111, v47
    v_smfmac_f32_32x32x32_bf16 v[96:111], v[200:203], v[184:191], v249 abid:1
    buffer_load_dword v178, v210, s[4:7], 0 offen
    buffer_load_dword v179, v211, s[4:7], 0 offen
    v_add_f32 v244, v244, v242
    v_cvt_pk_bf16_f32 v241, v241, v242
    ds_write_b32 v248, v241 offset:0
    s_waitcnt lgkmcnt(0)
    s_barrier
    v_xor_b32 v4, 8192, v4
    v_xor_b32 v5, 8192, v5
    ds_read_b64_tr_b16 v[192:193], v4 offset:0
    ds_read_b64_tr_b16 v[194:195], v4 offset:512
    ds_read_b64_tr_b16 v[196:197], v5 offset:0
    ds_read_b64_tr_b16 v[198:199], v5 offset:512
    ds_read_b128 v[208:211], v3 offset:320
    v_fma_f32 v241, v112, v48, -v245
    v_fmac_f32 v241, v113, v49
    v_fmac_f32 v241, v114, v50
    v_fmac_f32 v241, v115, v51
    v_fmac_f32 v241, v116, v52
    v_fmac_f32 v241, v117, v53
    v_fmac_f32 v241, v118, v54
    v_fmac_f32 v241, v119, v55
    v_fmac_f32 v241, v120, v56
    v_fmac_f32 v241, v121, v57
    v_fmac_f32 v241, v122, v58
    v_fmac_f32 v241, v123, v59
    v_fmac_f32 v241, v124, v60
    v_fmac_f32 v241, v125, v61
    v_fmac_f32 v241, v126, v62
    v_fmac_f32 v241, v127, v63
    s_waitcnt lgkmcnt(6)
    v_smfmac_f32_32x32x32_bf16 v[112:127], v[204:207], v[184:191], v249
    buffer_load_dword v180, v212, s[4:7], 0 offen
    buffer_load_dword v181, v213, s[4:7], 0 offen
    v_add_f32 v245, v245, v241
    ds_read_b64 v[226:227], v8 offset:26368
    ds_read_u16 v228, v8 offset:26886
    ds_read_u8 v229, v9 offset:24192
    v_fma_f32 v242, v128, v64, -v246
    v_fmac_f32 v242, v129, v65
    v_fmac_f32 v242, v130, v66
    v_fmac_f32 v242, v131, v67
    v_fmac_f32 v242, v132, v68
    v_fmac_f32 v242, v133, v69
    v_fmac_f32 v242, v134, v70
    v_fmac_f32 v242, v135, v71
    v_fmac_f32 v242, v136, v72
    v_fmac_f32 v242, v137, v73
    v_fmac_f32 v242, v138, v74
    v_fmac_f32 v242, v139, v75
    v_fmac_f32 v242, v140, v76
    v_fmac_f32 v242, v141, v77
    v_fmac_f32 v242, v142, v78
    v_fmac_f32 v242, v143, v79
    v_smfmac_f32_32x32x32_bf16 v[128:143], v[204:207], v[184:191], v249 abid:1
    buffer_load_dword v182, v214, s[4:7], 0 offen
    buffer_load_dword v183, v215, s[4:7], 0 offen
    v_add_f32 v246, v246, v242
    v_cvt_pk_bf16_f32 v241, v241, v242
    ds_write_b32 v248, v241 offset:1024
    v_add_u32 v248, s29, v10
    ds_read_b128 v[212:215], v3 offset:352
    s_branch K2_j11
K2_tail:
    s_setprio 0
    v_lshlrev_b32 v254, 4, v1
    s_mul_i32 s33, s3, 10240
    s_add_u32 s33, s33, 1048576
    s_add_u32 s34, s33, 4096
    s_add_u32 s35, s33, 8192
    buffer_load_dwordx4 v[144:147], v254, s[12:15], s33 offen offset:0 sc1
    buffer_load_dwordx4 v[148:151], v254, s[12:15], s33 offen offset:1024 sc1
    buffer_load_dwordx4 v[152:155], v254, s[12:15], s33 offen offset:2048 sc1
    buffer_load_dwordx4 v[156:159], v254, s[12:15], s33 offen offset:3072 sc1
    buffer_load_dwordx4 v[160:163], v254, s[12:15], s34 offen offset:0 sc1
    buffer_load_dwordx4 v[164:167], v254, s[12:15], s34 offen offset:1024 sc1
    buffer_load_dwordx4 v[168:171], v254, s[12:15], s34 offen offset:2048 sc1
    buffer_load_dwordx4 v[172:175], v254, s[12:15], s34 offen offset:3072 sc1
    buffer_load_dwordx4 v[176:179], v254, s[12:15], s35 offen offset:0 sc1
    buffer_load_dwordx4 v[180:183], v254, s[12:15], s35 offen offset:1024 sc1
    s_waitcnt lgkmcnt(0)
    v_fma_f32 v241, v80, v16, -v243
    v_fmac_f32 v241, v81, v17
    v_fmac_f32 v241, v82, v18
    v_fmac_f32 v241, v83, v19
    v_fmac_f32 v241, v84, v20
    v_fmac_f32 v241, v85, v21
    v_fmac_f32 v241, v86, v22
    v_fmac_f32 v241, v87, v23
    v_fmac_f32 v241, v88, v24
    v_fmac_f32 v241, v89, v25
    v_fmac_f32 v241, v90, v26
    v_fmac_f32 v241, v91, v27
    v_fmac_f32 v241, v92, v28
    v_fmac_f32 v241, v93, v29
    v_fmac_f32 v241, v94, v30
    v_fmac_f32 v241, v95, v31
    v_add_f32 v243, v243, v241
    v_fma_f32 v242, v96, v32, -v244
    v_fmac_f32 v242, v97, v33
    v_fmac_f32 v242, v98, v34
    v_fmac_f32 v242, v99, v35
    v_fmac_f32 v242, v100, v36
    v_fmac_f32 v242, v101, v37
    v_fmac_f32 v242, v102, v38
    v_fmac_f32 v242, v103, v39
    v_fmac_f32 v242, v104, v40
    v_fmac_f32 v242, v105, v41
    v_fmac_f32 v242, v106, v42
    v_fmac_f32 v242, v107, v43
    v_fmac_f32 v242, v108, v44
    v_fmac_f32 v242, v109, v45
    v_fmac_f32 v242, v110, v46
    v_fmac_f32 v242, v111, v47
    v_add_f32 v244, v244, v242
    v_cvt_pk_bf16_f32 v241, v241, v242
    ds_write_b32 v248, v241 offset:0
    v_fma_f32 v241, v112, v48, -v245
    v_fmac_f32 v241, v113, v49
    v_fmac_f32 v241, v114, v50
    v_fmac_f32 v241, v115, v51
    v_fmac_f32 v241, v116, v52
    v_fmac_f32 v241, v117, v53
    v_fmac_f32 v241, v118, v54
    v_fmac_f32 v241, v119, v55
    v_fmac_f32 v241, v120, v56
    v_fmac_f32 v241, v121, v57
    v_fmac_f32 v241, v122, v58
    v_fmac_f32 v241, v123, v59
    v_fmac_f32 v241, v124, v60
    v_fmac_f32 v241, v125, v61
    v_fmac_f32 v241, v126, v62
    v_fmac_f32 v241, v127, v63
    v_add_f32 v245, v245, v241
    v_fma_f32 v242, v128, v64, -v246
    v_fmac_f32 v242, v129, v65
    v_fmac_f32 v242, v130, v66
    v_fmac_f32 v242, v131, v67
    v_fmac_f32 v242, v132, v68
    v_fmac_f32 v242, v133, v69
    v_fmac_f32 v242, v134, v70
    v_fmac_f32 v242, v135, v71
    v_fmac_f32 v242, v136, v72
    v_fmac_f32 v242, v137, v73
    v_fmac_f32 v242, v138, v74
    v_fmac_f32 v242, v139, v75
    v_fmac_f32 v242, v140, v76
    v_fmac_f32 v242, v141, v77
    v_fmac_f32 v242, v142, v78
    v_fmac_f32 v242, v143, v79
    v_add_f32 v246, v246, v242
    v_cvt_pk_bf16_f32 v241, v241, v242
    ds_write_b32 v248, v241 offset:1024
    s_waitcnt vmcnt(10)
    s_branch K2_gemm2
K2_gemm:
    v_lshlrev_b32 v254, 4, v1
    s_mul_i32 s33, s3, 10240
    s_add_u32 s33, s33, 1048576
    s_add_u32 s34, s33, 4096
    s_add_u32 s35, s33, 8192
    buffer_load_dwordx4 v[144:147], v254, s[12:15], s33 offen offset:0 sc1
    buffer_load_dwordx4 v[148:151], v254, s[12:15], s33 offen offset:1024 sc1
    buffer_load_dwordx4 v[152:155], v254, s[12:15], s33 offen offset:2048 sc1
    buffer_load_dwordx4 v[156:159], v254, s[12:15], s33 offen offset:3072 sc1
    buffer_load_dwordx4 v[160:163], v254, s[12:15], s34 offen offset:0 sc1
    buffer_load_dwordx4 v[164:167], v254, s[12:15], s34 offen offset:1024 sc1
    buffer_load_dwordx4 v[168:171], v254, s[12:15], s34 offen offset:2048 sc1
    buffer_load_dwordx4 v[172:175], v254, s[12:15], s34 offen offset:3072 sc1
    buffer_load_dwordx4 v[176:179], v254, s[12:15], s35 offen offset:0 sc1
    buffer_load_dwordx4 v[180:183], v254, s[12:15], s35 offen offset:1024 sc1
K2_gemm2:
    v_lshlrev_b32 v252, 4, v0
    s_lshl_b32 s33, s2, 15
    s_add_u32 s33, s33, 16777216
    v_add_u32 v252, s33, v252
    s_cmp_lg_u32 s36, 0
    s_cbranch_scc1 K2_ldacc
    v_mov_b32 v184, 0
    v_mov_b32 v185, 0
    v_mov_b32 v186, 0
    v_mov_b32 v187, 0
    v_mov_b32 v188, 0
    v_mov_b32 v189, 0
    v_mov_b32 v190, 0
    v_mov_b32 v191, 0
    v_mov_b32 v192, 0
    v_mov_b32 v193, 0
    v_mov_b32 v194, 0
    v_mov_b32 v195, 0
    v_mov_b32 v196, 0
    v_mov_b32 v197, 0
    v_mov_b32 v198, 0
    v_mov_b32 v199, 0
    v_mov_b32 v200, 0
    v_mov_b32 v201, 0
    v_mov_b32 v202, 0
    v_mov_b32 v203, 0
    v_mov_b32 v204, 0
    v_mov_b32 v205, 0
    v_mov_b32 v206, 0
    v_mov_b32 v207, 0
    v_mov_b32 v208, 0
    v_mov_b32 v209, 0
    v_mov_b32 v210, 0
    v_mov_b32 v211, 0
    v_mov_b32 v212, 0
    v_mov_b32 v213, 0
    v_mov_b32 v214, 0
    v_mov_b32 v215, 0
    s_branch K2_ldacc_done
K2_ldacc:
    s_movk_i32 s34, 0
    buffer_load_dwordx4 v[184:187], v252, s[12:15], s34 offen
    s_movk_i32 s34, 4096
    buffer_load_dwordx4 v[188:191], v252, s[12:15], s34 offen
    s_movk_i32 s34, 8192
    buffer_load_dwordx4 v[192:195], v252, s[12:15], s34 offen
    s_movk_i32 s34, 12288
    buffer_load_dwordx4 v[196:199], v252, s[12:15], s34 offen
    s_movk_i32 s34, 16384
    buffer_load_dwordx4 v[200:203], v252, s[12:15], s34 offen
    s_movk_i32 s34, 20480
    buffer_load_dwordx4 v[204:207], v252, s[12:15], s34 offen
    s_movk_i32 s34, 24576
    buffer_load_dwordx4 v[208:211], v252, s[12:15], s34 offen
    s_movk_i32 s34, 28672
    buffer_load_dwordx4 v[212:215], v252, s[12:15], s34 offen
K2_ldacc_done:
    v_and_b32 v254, 15, v1
    v_and_or_b32 v253, v254, 3, 16
    v_and_b32 v220, 12, v254
    v_lshrrev_b32 v255, 4, v1
    v_lshlrev_b32 v255, 4, v255
    v_add_u32 v255, 40640, v255
    v_mul_u32_u24 v254, 2064, v254
    v_add_u32 v254, v254, v255
    v_mul_u32_u24 v253, 2064, v253
    v_add_u32 v253, v253, v255
    s_mov_b32 s34, 0xcc84
    v_bfe_u32 v216, s34, v220, 4
    v_lshl_add_u32 v216, v216, 7, v253
    s_movk_i32 s34, 0x3321
    v_bfe_u32 v217, s34, v220, 4
    v_lshl_add_u32 v217, v217, 7, v253
    s_movk_i32 s34, 0x66db
    v_bfe_u32 v218, s34, v220, 4
    v_lshl_add_u32 v218, v218, 7, v253
    s_mov_b32 s34, 0x997e
    v_bfe_u32 v219, s34, v220, 4
    v_lshl_add_u32 v219, v219, 7, v253
    s_waitcnt lgkmcnt(0)
    s_barrier
    ds_read_b128 v[80:83], v254 offset:0
    ds_read_b128 v[84:87], v253 offset:0
    ds_read_b128 v[88:91], v254 offset:512
    ds_read_b128 v[92:95], v216 offset:0
    ds_read_b128 v[96:99], v254 offset:1024
    ds_read_b128 v[100:103], v254 offset:1536
    ds_read_b128 v[104:107], v254 offset:64
    ds_read_b128 v[108:111], v253 offset:64
    ds_read_b128 v[112:115], v254 offset:576
    ds_read_b128 v[116:119], v216 offset:64
    ds_read_b128 v[120:123], v254 offset:1088
    ds_read_b128 v[124:127], v254 offset:1600
    s_waitcnt vmcnt(0)
    s_waitcnt lgkmcnt(11)
    v_mfma_f32_16x16x32_bf16 v[184:187], v[144:147], v[80:83], v[184:187]
    ds_read_b128 v[128:131], v254 offset:640
    s_waitcnt lgkmcnt(11)
    v_mfma_f32_16x16x32_bf16 v[200:203], v[144:147], v[84:87], v[200:203]
    ds_read_b128 v[132:135], v253 offset:640
    s_waitcnt lgkmcnt(11)
    v_mfma_f32_16x16x32_bf16 v[188:191], v[160:163], v[88:91], v[188:191]
    ds_read_b128 v[136:139], v254 offset:128
    s_waitcnt lgkmcnt(11)
    v_mfma_f32_16x16x32_bf16 v[204:207], v[160:163], v[92:95], v[204:207]
    ds_read_b128 v[140:143], v217 offset:0
    s_waitcnt lgkmcnt(11)
    v_mfma_f32_16x16x32_bf16 v[192:195], v[160:163], v[96:99], v[192:195]
    ds_read_b128 v[80:83], v254 offset:256
    s_waitcnt lgkmcnt(11)
    v_mfma_f32_16x16x32_bf16 v[196:199], v[160:163], v[100:103], v[196:199]
    ds_read_b128 v[84:87], v254 offset:384
    s_waitcnt lgkmcnt(11)
    v_mfma_f32_16x16x32_bf16 v[184:187], v[148:151], v[104:107], v[184:187]
    ds_read_b128 v[88:91], v254 offset:704
    s_waitcnt lgkmcnt(11)
    v_mfma_f32_16x16x32_bf16 v[200:203], v[148:151], v[108:111], v[200:203]
    ds_read_b128 v[92:95], v253 offset:704
    s_waitcnt lgkmcnt(11)
    v_mfma_f32_16x16x32_bf16 v[188:191], v[164:167], v[112:115], v[188:191]
    ds_read_b128 v[96:99], v254 offset:192
    s_waitcnt lgkmcnt(11)
    v_mfma_f32_16x16x32_bf16 v[204:207], v[164:167], v[116:119], v[204:207]
    ds_read_b128 v[100:103], v217 offset:64
    s_waitcnt lgkmcnt(11)
    v_mfma_f32_16x16x32_bf16 v[192:195], v[164:167], v[120:123], v[192:195]
    ds_read_b128 v[104:107], v254 offset:320
    s_waitcnt lgkmcnt(11)
    v_mfma_f32_16x16x32_bf16 v[196:199], v[164:167], v[124:127], v[196:199]
    ds_read_b128 v[108:111], v254 offset:448
    s_waitcnt lgkmcnt(11)
    v_mfma_f32_16x16x32_bf16 v[184:187], v[152:155], v[128:131], v[184:187]
    ds_read_b128 v[112:115], v254 offset:1280
    s_waitcnt lgkmcnt(11)
    v_mfma_f32_16x16x32_bf16 v[200:203], v[152:155], v[132:135], v[200:203]
    ds_read_b128 v[116:119], v253 offset:1280
    s_waitcnt lgkmcnt(11)
    v_mfma_f32_16x16x32_bf16 v[188:191], v[168:171], v[136:139], v[188:191]
    ds_read_b128 v[120:123], v254 offset:1408
    s_waitcnt lgkmcnt(11)
    v_mfma_f32_16x16x32_bf16 v[204:207], v[168:171], v[140:143], v[204:207]
    ds_read_b128 v[124:127], v218 offset:0
    s_waitcnt lgkmcnt(11)
    v_mfma_f32_16x16x32_bf16 v[192:195], v[168:171], v[80:83], v[192:195]
    ds_read_b128 v[128:131], v254 offset:1664
    s_waitcnt lgkmcnt(11)
    v_mfma_f32_16x16x32_bf16 v[196:199], v[168:171], v[84:87], v[196:199]
    ds_read_b128 v[132:135], v254 offset:768
    s_waitcnt lgkmcnt(11)
    v_mfma_f32_16x16x32_bf16 v[184:187], v[156:159], v[88:91], v[184:187]
    ds_read_b128 v[136:139], v254 offset:1344
    s_waitcnt lgkmcnt(11)
    v_mfma_f32_16x16x32_bf16 v[200:203], v[156:159], v[92:95], v[200:203]
    ds_read_b128 v[140:143], v253 offset:1344
    s_waitcnt lgkmcnt(11)
    v_mfma_f32_16x16x32_bf16 v[188:191], v[172:175], v[96:99], v[188:191]
    ds_read_b128 v[80:83], v254 offset:1472
    s_waitcnt lgkmcnt(11)
    v_mfma_f32_16x16x32_bf16 v[204:207], v[172:175], v[100:103], v[204:207]
    ds_read_b128 v[84:87], v218 offset:64
    s_waitcnt lgkmcnt(11)
    v_mfma_f32_16x16x32_bf16 v[192:195], v[172:175], v[104:107], v[192:195]
    ds_read_b128 v[88:91], v254 offset:1728
    s_waitcnt lgkmcnt(11)
    v_mfma_f32_16x16x32_bf16 v[196:199], v[172:175], v[108:111], v[196:199]
    ds_read_b128 v[92:95], v254 offset:832
    s_waitcnt lgkmcnt(11)
    v_mfma_f32_16x16x32_bf16 v[184:187], v[152:155], v[112:115], v[184:187]
    ds_read_b128 v[96:99], v254 offset:1920
    s_waitcnt lgkmcnt(11)
    v_mfma_f32_16x16x32_bf16 v[200:203], v[152:155], v[116:119], v[200:203]
    ds_read_b128 v[100:103], v253 offset:1920
    s_waitcnt lgkmcnt(11)
    v_mfma_f32_16x16x32_bf16 v[188:191], v[176:179], v[120:123], v[188:191]
    ds_read_b128 v[104:107], v254 offset:1792
    s_waitcnt lgkmcnt(11)
    v_mfma_f32_16x16x32_bf16 v[204:207], v[176:179], v[124:127], v[204:207]
    ds_read_b128 v[108:111], v219 offset:0
    s_waitcnt lgkmcnt(11)
    v_mfma_f32_16x16x32_bf16 v[192:195], v[176:179], v[128:131], v[192:195]
    ds_read_b128 v[112:115], v254 offset:896
    s_waitcnt lgkmcnt(11)
    v_mfma_f32_16x16x32_bf16 v[196:199], v[176:179], v[132:135], v[196:199]
    ds_read_b128 v[116:119], v254 offset:1152
    s_waitcnt lgkmcnt(11)
    v_mfma_f32_16x16x32_bf16 v[184:187], v[156:159], v[136:139], v[184:187]
    ds_read_b128 v[120:123], v254 offset:1984
    s_waitcnt lgkmcnt(11)
    v_mfma_f32_16x16x32_bf16 v[200:203], v[156:159], v[140:143], v[200:203]
    ds_read_b128 v[124:127], v253 offset:1984
    s_waitcnt lgkmcnt(11)
    v_mfma_f32_16x16x32_bf16 v[188:191], v[180:183], v[80:83], v[188:191]
    ds_read_b128 v[128:131], v254 offset:1856
    s_waitcnt lgkmcnt(11)
    v_mfma_f32_16x16x32_bf16 v[204:207], v[180:183], v[84:87], v[204:207]
    ds_read_b128 v[132:135], v219 offset:64
    s_waitcnt lgkmcnt(11)
    v_mfma_f32_16x16x32_bf16 v[192:195], v[180:183], v[88:91], v[192:195]
    ds_read_b128 v[136:139], v254 offset:960
    s_waitcnt lgkmcnt(11)
    v_mfma_f32_16x16x32_bf16 v[196:199], v[180:183], v[92:95], v[196:199]
    ds_read_b128 v[140:143], v254 offset:1216
    s_waitcnt lgkmcnt(11)
    v_mfma_f32_16x16x32_bf16 v[184:187], v[152:155], v[96:99], v[184:187]
    s_waitcnt lgkmcnt(10)
    v_mfma_f32_16x16x32_bf16 v[200:203], v[152:155], v[100:103], v[200:203]
    s_waitcnt lgkmcnt(9)
    v_mfma_f32_16x16x32_bf16 v[188:191], v[176:179], v[104:107], v[188:191]
    s_waitcnt lgkmcnt(8)
    v_mfma_f32_16x16x32_bf16 v[204:207], v[176:179], v[108:111], v[204:207]
    s_waitcnt lgkmcnt(7)
    v_mfma_f32_16x16x32_bf16 v[192:195], v[176:179], v[112:115], v[192:195]
    s_waitcnt lgkmcnt(6)
    v_mfma_f32_16x16x32_bf16 v[196:199], v[176:179], v[116:119], v[196:199]
    s_waitcnt lgkmcnt(5)
    v_mfma_f32_16x16x32_bf16 v[184:187], v[156:159], v[120:123], v[184:187]
    s_waitcnt lgkmcnt(4)
    v_mfma_f32_16x16x32_bf16 v[200:203], v[156:159], v[124:127], v[200:203]
    s_waitcnt lgkmcnt(3)
    v_mfma_f32_16x16x32_bf16 v[188:191], v[180:183], v[128:131], v[188:191]
    s_waitcnt lgkmcnt(2)
    v_mfma_f32_16x16x32_bf16 v[204:207], v[180:183], v[132:135], v[204:207]
    s_waitcnt lgkmcnt(1)
    v_mfma_f32_16x16x32_bf16 v[192:195], v[180:183], v[136:139], v[192:195]
    s_waitcnt lgkmcnt(0)
    v_mfma_f32_16x16x32_bf16 v[196:199], v[180:183], v[140:143], v[196:199]
    s_cmp_eq_u32 s32, 0
    s_cbranch_scc1 K2_out
    s_movk_i32 s34, 0
    buffer_store_dwordx4 v[184:187], v252, s[12:15], s34 offen
    s_movk_i32 s34, 4096
    buffer_store_dwordx4 v[188:191], v252, s[12:15], s34 offen
    s_movk_i32 s34, 8192
    buffer_store_dwordx4 v[192:195], v252, s[12:15], s34 offen
    s_movk_i32 s34, 12288
    buffer_store_dwordx4 v[196:199], v252, s[12:15], s34 offen
    s_movk_i32 s34, 16384
    buffer_store_dwordx4 v[200:203], v252, s[12:15], s34 offen
    s_movk_i32 s34, 20480
    buffer_store_dwordx4 v[204:207], v252, s[12:15], s34 offen
    s_movk_i32 s34, 24576
    buffer_store_dwordx4 v[208:211], v252, s[12:15], s34 offen
    s_movk_i32 s34, 28672
    buffer_store_dwordx4 v[212:215], v252, s[12:15], s34 offen
    v_sub_u32 v13, v13, v15
    v_mad_u32_u24 v14, v15, 16, v14
    s_mov_b32 s36, 1
    s_waitcnt vmcnt(0)
    s_barrier
    s_branch K2_batch
K2_out:
    v_and_b32 v254, 15, v1
    v_cmp_gt_u32 vcc, 4, v254
    v_lshlrev_b32 v254, 9, v254
    v_lshrrev_b32 v255, 4, v1
    v_lshl_add_u32 v254, v255, 3, v254
    s_mul_i32 s33, s24, 10240
    s_lshl_b32 s34, s3, 5
    s_add_u32 s33, s33, s34
    s_add_u32 s34, s33, 8192
    v_and_b32 v253, 0x7ff, v254
    v_lshl_add_u32 v253, v220, 5, v253
    v_cmp_gt_u32 s[52:53], 12, v220
    v_mul_f32 v80, 0xbfb8aa3b, v184
    v_mul_f32 v81, 0xbfb8aa3b, v185
    v_mul_f32 v82, 0xbfb8aa3b, v186
    v_mul_f32 v83, 0xbfb8aa3b, v187
    v_exp_f32 v80, v80
    v_exp_f32 v81, v81
    v_exp_f32 v82, v82
    v_exp_f32 v83, v83
    v_add_f32 v80, 1.0, v80
    v_add_f32 v81, 1.0, v81
    v_add_f32 v82, 1.0, v82
    v_add_f32 v83, 1.0, v83
    v_rcp_f32 v80, v80
    v_rcp_f32 v81, v81
    v_rcp_f32 v82, v82
    v_rcp_f32 v83, v83
    v_mul_f32 v188, v188, v80
    v_mul_f32 v189, v189, v81
    v_mul_f32 v190, v190, v82
    v_mul_f32 v191, v191, v83
    v_mul_f32 v192, v192, v80
    v_mul_f32 v193, v193, v81
    v_mul_f32 v194, v194, v82
    v_mul_f32 v195, v195, v83
    v_mul_f32 v196, v196, v80
    v_mul_f32 v197, v197, v81
    v_mul_f32 v198, v198, v82
    v_mul_f32 v199, v199, v83
    v_cvt_pk_bf16_f32 v88, v184, v185
    v_cvt_pk_bf16_f32 v89, v186, v187
    v_cvt_pk_bf16_f32 v90, v188, v189
    v_cvt_pk_bf16_f32 v91, v190, v191
    v_cvt_pk_bf16_f32 v92, v192, v193
    v_cvt_pk_bf16_f32 v93, v194, v195
    v_cvt_pk_bf16_f32 v94, v196, v197
    v_cvt_pk_bf16_f32 v95, v198, v199
    buffer_store_dwordx2 v[88:89], v254, s[20:23], s33 offen offset:0
    buffer_store_dwordx2 v[90:91], v254, s[20:23], s33 offen offset:128
    buffer_store_dwordx2 v[92:93], v254, s[20:23], s33 offen offset:256
    buffer_store_dwordx2 v[94:95], v254, s[20:23], s33 offen offset:384
    v_mul_f32 v96, 0xbfb8aa3b, v200
    v_mul_f32 v97, 0xbfb8aa3b, v201
    v_mul_f32 v98, 0xbfb8aa3b, v202
    v_mul_f32 v99, 0xbfb8aa3b, v203
    v_exp_f32 v96, v96
    v_exp_f32 v97, v97
    v_exp_f32 v98, v98
    v_exp_f32 v99, v99
    v_add_f32 v96, 1.0, v96
    v_add_f32 v97, 1.0, v97
    v_add_f32 v98, 1.0, v98
    v_add_f32 v99, 1.0, v99
    v_rcp_f32 v96, v96
    v_rcp_f32 v97, v97
    v_rcp_f32 v98, v98
    v_rcp_f32 v99, v99
    v_mul_f32 v204, v204, v96
    v_mul_f32 v205, v205, v97
    v_mul_f32 v206, v206, v98
    v_mul_f32 v207, v207, v99
    v_cvt_pk_bf16_f32 v104, v200, v201
    v_cvt_pk_bf16_f32 v105, v202, v203
    v_cvt_pk_bf16_f32 v106, v204, v205
    v_cvt_pk_bf16_f32 v107, v206, v207
    s_mov_b64 exec, s[52:53]
    buffer_store_dwordx2 v[106:107], v253, s[20:23], s34 offen offset:128
    s_mov_b64 exec, vcc
    buffer_store_dwordx2 v[104:105], v254, s[20:23], s34 offen
K2_end:
    s_endpgm
.section .rodata,"a"
.p2align 6
.amdhsa_kernel gather_scatter__tensor_product_equiv_equiformer__graph_kernel
  .amdhsa_next_free_vgpr 256
  .amdhsa_next_free_sgpr 102
  .amdhsa_accum_offset 256
  .amdhsa_group_segment_fixed_size 0
  .amdhsa_kernarg_size 96
  .amdhsa_user_sgpr_count 2
  .amdhsa_user_sgpr_kernarg_segment_ptr 1
  .amdhsa_system_sgpr_workgroup_id_x 1
.end_amdhsa_kernel
```
